```python
import torch

def _softmax(x, axis=-1):
    return torch.softmax(x, dim=axis)
def _gelu(x):
    return torch.nn.functional.gelu(x, approximate="tanh")
def _silu(x):
    return torch.nn.functional.silu(x)
def _sigmoid(x):
    return torch.sigmoid(x)
def _layernorm(x, axis=-1, eps=1e-5):
    m = x.mean(dim=axis, keepdim=True)
    v = x.var(dim=axis, keepdim=True, unbiased=False)
    return (x - m) / torch.sqrt(v + eps)
def _scatter_add(tgt, idx, src, axis=0):
    return tgt.clone().index_add_(axis, idx, src)
def _segment_sum(src, seg, n):
    out = torch.zeros((n,) + src.shape[1:], dtype=src.dtype)
    return out.index_add_(0, seg, src)
def _pad(x, pw):
    flat = tuple(v for pair in reversed(pw) for v in pair)
    return torch.nn.functional.pad(x, flat)

kernel_name = 'sequential_preLN__grouped_kv_mqa__dense_activation_relu__prompt'

def setup_inputs():

    _w = (lambda a: (lambda t: t.to(torch.bfloat16) if t.is_floating_point() else t)(torch.as_tensor(a)))
    def _A_setup():
        B, S, D, H = 1, 2048, 640, 32
        Dh = D // H
        return {
            "x": _w((lambda *s: torch.randn(*s, dtype=torch.bfloat16) * 0.05)(B, S, D)),
            "wq": _w((lambda *s: torch.randn(*s, dtype=torch.bfloat16) * 0.05)(D, H * Dh)),
            "wk": _w((lambda *s: torch.randn(*s, dtype=torch.bfloat16) * 0.05)(D, Dh)),
            "wv": _w((lambda *s: torch.randn(*s, dtype=torch.bfloat16) * 0.05)(D, Dh)),
            "wo": _w((lambda *s: torch.randn(*s, dtype=torch.bfloat16) * 0.05)(H * Dh, D)),
        }
    _A_in = _A_setup()

    def _B_setup():
        B, S, D, Dff = 1, 2048, 640, 1536
        return {
            "x": _w((lambda *s: torch.randn(*s, dtype=torch.bfloat16) * 0.05)(B, S, D)),
            "w1": _w((lambda *s: torch.randn(*s, dtype=torch.bfloat16) * 0.05)(D, Dff)),
            "w2": _w((lambda *s: torch.randn(*s, dtype=torch.bfloat16) * 0.05)(Dff, D)),
        }
    _B_in = _B_setup()

    return {
        "A_x": _A_in["x"],
        "A_wq": _A_in["wq"],
        "A_wk": _A_in["wk"],
        "A_wv": _A_in["wv"],
        "A_wo": _A_in["wo"],
        "B_x": _B_in["x"],
        "B_w1": _B_in["w1"],
        "B_w2": _B_in["w2"],
    }

def reference(A_x, A_wq, A_wk, A_wv, A_wo, B_x, B_w1, B_w2):
    def _A_ref(x, wq, wk, wv, wo):
        B, S, D = x.shape
        H = 32
        Dh = D // H
        q = (lambda x, *d: x.permute(*d))((x @ wq).reshape(B, S, H, Dh), 0, 2, 1, 3)
        k = x @ wk
        v = x @ wv
        scores = torch.einsum("bhqd,bkd->bhqk", q, k) * (Dh ** -0.5)
        p = _softmax(scores, axis=-1)
        o = torch.einsum("bhqk,bkd->bhqd", p, v)
        return (lambda x, *d: x.permute(*d))(o, 0, 2, 1, 3).reshape(B, S, H * Dh) @ wo

    def _B_ref(x, w1, w2):
        h = torch.einsum("bsd,df->bsf", x, w1)
        zero = torch.zeros_like(h)
        h = torch.maximum(h, zero)
        return torch.einsum("bsf,fd->bsd", h, w2)

    x = A_x
    h = x + _A_ref(_layernorm(x, axis=-1), A_wq, A_wk, A_wv, A_wo)
    h2 = h + _B_ref(_layernorm(h, axis=-1), B_w1, B_w2)
    return h2
```

```asm
; @launch grid=(256,1,1) block=(512,1,1) lds=163840
.amdgcn_target "amdgcn-amd-amdhsa--gfx950"
.text
.globl sequential_preLN__grouped_kv_mqa__dense_activation_relu__prompt_kernel
.p2align 12
.p2align 8
.type sequential_preLN__grouped_kv_mqa__dense_activation_relu__prompt_kernel,@function
sequential_preLN__grouped_kv_mqa__dense_activation_relu__prompt_kernel:
    s_cmp_ge_u32 s2, 256
    s_cbranch_scc1 L_end
    s_load_dwordx16 s[48:63], s[0:1], 0
    s_load_dwordx4 s[64:67], s[0:1], 64
    s_load_dwordx2 s[68:69], s[0:1], 80
    v_lshrrev_b32 v2, 6, v0
    v_and_b32 v0, 63, v0
    v_readfirstlane_b32 s38, v2
    v_lshlrev_b32 v1, 4, v0
    s_cmp_lg_u32 s38, 7
    s_cbranch_scc1 L_nowarm
    s_getpc_b64 s[40:41]
L_pc:
    s_lshr_b32 s70, s2, 3
    s_lshl_b32 s70, s70, 11
    s_min_u32 s70, s70, L_code_end-L_pc-2052
    s_add_u32 s40, s40, s70
    s_addc_u32 s41, s41, 0
    v_lshlrev_b32 v84, 1, v1
    v_mov_b32 v85, s41
    v_add_co_u32 v84, vcc, s40, v84
    s_nop 1
    v_addc_co_u32 v85, vcc, 0, v85, vcc
    global_load_dword v5, v[84:85], off
L_nowarm:
    v_mov_b32 v86, 0
    v_and_b32 v88, 15, v0
    v_lshlrev_b32 v88, 2, v88
    v_add_u32 v88, 159872, v88
    ds_write_b32 v88, v86
    s_and_b32 s36, s2, 7
    s_lshl_b32 s36, s36, 2
    s_lshr_b32 s70, s2, 6
    s_add_u32 s36, s36, s70
    s_lshr_b32 s37, s2, 3
    s_and_b32 s37, s37, 7
    s_lshr_b32 s44, s38, 2
    s_and_b32 s45, s38, 3
    s_lshl_b32 s70, s37, 1
    s_lshr_b32 s71, s37, 2
    s_add_u32 s71, s71, s70
    s_add_u32 s71, s71, s38
    s_and_b32 s71, s71, 3
    s_xor_b32 s70, s70, s38
    s_and_b32 s70, s70, 4
    s_or_b32 s71, s71, s70
    s_lshl_b32 s71, s71, 3
    s_mul_i32 s74, s71, 1280
    s_mul_i32 s72, s36, 81920
    s_add_u32 s72, s72, s74
    v_lshrrev_b32 v80, 4, v0
    v_add_u32 v79, s71, v80
    v_xor_b32 v81, v79, v0
    v_and_b32 v81, 15, v81
    v_lshlrev_b32 v81, 4, v81
    v_mul_u32_u24 v77, 1280, v80
    v_add_u32 v77, v77, v81
    v_xor_b32 v78, 64, v77
    v_add_u32 v78, 5120, v78
    s_or_b32 s70, s37, s38
    s_cmp_lt_u32 s70, 4
    s_cselect_b32 s39, 2, 0
    s_lshl_b32 s5, s36, 3
    s_add_u32 s5, s5, s37
    s_mul_i32 s73, s38, 7168
    s_mul_i32 s70, s38, 6400
    s_mov_b32 s10, 2621440
    s_mov_b32 s11, 0x00020000
    s_mov_b32 s18, 25600
    s_mov_b32 s19, 0x00020000
    s_mov_b32 s14, 819200
    s_mov_b32 s15, 0x00020000
    s_add_u32 m0, s73, 131072
    s_bitcmp1_b32 s37, 0
    s_waitcnt lgkmcnt(0)
    s_barrier
    s_cselect_b32 s16, s54, s52
    s_cselect_b32 s17, s55, s53
    s_mov_b32 s8, s48
    s_mov_b32 s9, s49
    s_mov_b32 s12, s50
    s_mov_b32 s13, s51
    s_cmp_lg_u32 s44, 0
    s_cbranch_scc1 L_setup
    s_setprio 2
    s_cmp_eq_u32 s39, 0
    s_cbranch_scc1 L_nowk
    s_add_u32 s75, s70, 4096
    buffer_load_dwordx4 v1, s[16:19], s70 offen offset:0 lds
    buffer_load_dwordx4 v1, s[16:19], s70 offen offset:1024 lds
    buffer_load_dwordx4 v1, s[16:19], s70 offen offset:2048 lds
    buffer_load_dwordx4 v1, s[16:19], s70 offen offset:3072 lds
    s_add_u32 m0, s73, 135168
    s_nop 0
    buffer_load_dwordx4 v1, s[16:19], s75 offen offset:0 lds
    buffer_load_dwordx4 v1, s[16:19], s75 offen offset:1024 lds
    buffer_load_dwordx4 v1, s[16:19], s75 offen offset:2048 lds
    s_branch L_x7
L_nowk:
    s_add_u32 m0, s74, 0
    s_nop 0
    buffer_load_dwordx4 v77, s[8:11], s72 offen offset:0 lds
    s_add_u32 m0, s74, 768
    s_nop 0
    buffer_load_dwordx4 v77, s[8:11], s72 offen offset:256 lds
    s_add_u32 m0, s74, 1536
    s_nop 0
    buffer_load_dwordx4 v77, s[8:11], s72 offen offset:512 lds
    s_add_u32 m0, s74, 2304
    s_nop 0
    buffer_load_dwordx4 v77, s[8:11], s72 offen offset:768 lds
    s_add_u32 m0, s74, 3072
    s_nop 0
    buffer_load_dwordx4 v77, s[8:11], s72 offen offset:1024 lds
    s_add_u32 m0, s74, 5120
    s_nop 0
    buffer_load_dwordx4 v78, s[8:11], s72 offen offset:0 lds
    s_add_u32 m0, s74, 5888
    s_nop 0
    buffer_load_dwordx4 v78, s[8:11], s72 offen offset:256 lds
L_x7:
    s_add_u32 m0, s74, 6656
    s_nop 0
    buffer_load_dwordx4 v78, s[8:11], s72 offen offset:512 lds
    s_add_u32 m0, s74, 7424
    s_nop 0
    buffer_load_dwordx4 v78, s[8:11], s72 offen offset:768 lds
    s_add_u32 m0, s74, 8192
    s_nop 0
    buffer_load_dwordx4 v78, s[8:11], s72 offen offset:1024 lds
L_setup:
    s_mov_b32 s32, s68
    s_mov_b32 s33, s69
    s_mov_b32 s34, 25165824
    s_mov_b32 s35, 0x00020000
    s_mov_b32 s28, s66
    s_mov_b32 s29, s67
    s_mov_b32 s30, 256
    s_mov_b32 s31, 0x00020000
    s_mov_b32 s24, s64
    s_mov_b32 s25, s65
    s_mov_b32 s26, 2621440
    s_mov_b32 s27, 0x00020000
    s_mov_b32 s20, s56
    s_mov_b32 s21, s57
    s_mov_b32 s22, 819200
    s_mov_b32 s23, 0x00020000
    s_mov_b32 s42, 0x3f803f80
    s_lshl_b32 s77, s38, 10
    s_lshr_b32 s69, s2, 6
    s_and_b32 s70, s37, 1
    s_add_u32 s69, s69, s70
    v_lshlrev_b32 v79, 2, v79
    v_add_u32 v79, 160000, v79
    v_lshrrev_b32 v86, 5, v0
    v_lshlrev_b32 v92, 3, v86
    v_bfe_u32 v87, v0, 2, 2
    v_add_u32 v92, v92, v87
    v_and_b32 v93, 3, v0
    v_and_b32 v87, 16, v0
    v_cmp_ne_u32 vcc, 0, v87
    v_lshlrev_b32 v88, 8, v93
    v_bfe_u32 v87, v0, 2, 3
    v_cndmask_b32 v93, v93, 4, vcc
    v_lshlrev_b32 v93, 3, v93
    v_mul_u32_u24 v94, 5120, v87
    v_xor_b32 v86, v86, v0
    v_and_b32 v86, 15, v86
    v_lshlrev_b32 v86, 4, v86
    v_add3_u32 v94, v94, v88, v86
    v_cmp_gt_u32 s[90:91], 32, v0
    s_xor_b32 s70, s38, 4
    s_or_b32 s70, s2, s70
    s_cmp_lg_u32 s70, 0
    s_cbranch_scc1 L_notok
    s_setprio 3
    s_memrealtime s[40:41]
    s_waitcnt lgkmcnt(0)
    s_or_b32 s40, s40, 1
    s_or_b32 s41, s41, 0x40000000
    v_mov_b32 v86, s40
    v_mov_b32 v87, s41
    s_mov_b64 exec, 1
    buffer_store_dwordx2 v[86:87], off, s[28:31], 0 sc1
    s_mov_b64 exec, -1
    s_setprio 0
L_notok:
    s_add_u32 s71, s73, 131072
    v_mul_u32_u24 v89, 40, v92
    v_add3_u32 v89, v89, v93, s71
    s_mul_i32 s71, s37, 160
    s_mul_i32 s73, s45, 6144
    s_mul_i32 s75, s45, 40960
    v_mov_b32 v85, 0x7f000000
    v_add_u32 v86, 0, v0
    v_mul_u32_u24 v87, 43691, v86
    v_lshrrev_b32 v87, 19, v87
    v_mul_u32_u24 v88, 12, v87
    v_sub_u32 v88, v86, v88
    v_cmp_gt_u32 vcc, 10, v88
    v_mul_u32_u24 v87, 1280, v87
    v_lshlrev_b32 v88, 4, v88
    v_add3_u32 v72, v88, v87, s71
    v_cndmask_b32 v72, v85, v72, vcc
    v_add_u32 v86, 64, v0
    v_mul_u32_u24 v87, 43691, v86
    v_lshrrev_b32 v87, 19, v87
    v_mul_u32_u24 v88, 12, v87
    v_sub_u32 v88, v86, v88
    v_cmp_gt_u32 vcc, 10, v88
    v_mul_u32_u24 v87, 1280, v87
    v_lshlrev_b32 v88, 4, v88
    v_add3_u32 v73, v88, v87, s71
    v_cndmask_b32 v73, v85, v73, vcc
    v_add_u32 v86, 128, v0
    v_mul_u32_u24 v87, 43691, v86
    v_lshrrev_b32 v87, 19, v87
    v_mul_u32_u24 v88, 12, v87
    v_sub_u32 v88, v86, v88
    v_cmp_gt_u32 vcc, 10, v88
    v_mul_u32_u24 v87, 1280, v87
    v_lshlrev_b32 v88, 4, v88
    v_add3_u32 v74, v88, v87, s71
    v_cndmask_b32 v74, v85, v74, vcc
    s_lshl_b32 s43, s36, 2
    s_and_b32 s0, s37, 3
    s_add_u32 s43, s43, s0
    s_cmp_lt_u32 s37, 4
    s_cselect_b32 s0, 128, 0
    s_add_u32 s43, s43, s0
    s_cmp_ge_u32 s43, 96
    s_cbranch_scc1 L_t_1_w2
    s_mov_b32 s20, s60
    s_mov_b32 s21, s61
    s_mov_b32 s22, 1966080
    s_mov_b32 s23, 0x00020000
    s_sub_u32 s0, s43, 0
    s_mul_i32 s1, s0, 2731
    s_lshr_b32 s1, s1, 16
    s_mul_i32 s68, s1, 24
    s_sub_u32 s0, s0, s68
    s_mov_b32 s86, 3072
    s_mov_b32 s89, 5
    s_mul_i32 s87, s1, 491520
    s_lshl_b32 s68, s0, 7
    s_add_u32 s87, s87, s68
    s_lshl_b32 s0, s0, 2
    s_add_u32 s0, s0, s45
    s_lshl_b32 s68, s0, 2
    s_add_u32 s68, s68, s1
    s_lshl_b32 s68, s68, 1
    s_add_u32 s68, s68, s44
    s_lshl_b32 s68, s68, 6
    s_add_u32 s62, s68, 524288
    s_mul_i32 s0, s0, 20
    s_mul_i32 s1, s1, 5
    s_add_u32 s0, s0, s1
    s_add_u32 s0, s0, s44
    s_lshl_b32 s0, s0, 10
    s_add_u32 s88, s0, 2097152
    s_cmp_eq_u32 s44, 0
    s_mov_b32 s68, 0x2c282420
    s_cselect_b32 s80, 0x0c080400, s68
    s_mov_b32 s68, 0x3c383430
    s_cselect_b32 s81, 0x1c181410, s68
    s_mov_b32 s68, 0x7c787470
    s_cselect_b32 s82, 0x5c585450, s68
    s_mov_b32 s68, 0x8c888480
    s_cselect_b32 s83, 0x6c686460, s68
    s_mov_b32 s68, 0x00000000
    s_cselect_b32 s84, 0x98904840, s68
    s_mov_b32 s68, 0x00000000
    s_cselect_b32 s85, 0x9c944c44, s68
    s_branch L_t_1_j
L_t_1_w2:
    s_cmp_ge_u32 s43, 176
    s_cbranch_scc1 L_t_1_wo
    s_mov_b32 s20, s62
    s_mov_b32 s21, s63
    s_mov_b32 s22, 1966080
    s_mov_b32 s23, 0x00020000
    s_sub_u32 s0, s43, 96
    s_mul_i32 s1, s0, 6554
    s_lshr_b32 s1, s1, 16
    s_mul_i32 s68, s1, 10
    s_sub_u32 s0, s0, s68
    s_mov_b32 s86, 1280
    s_mov_b32 s89, 6
    s_mul_i32 s87, s1, 245760
    s_lshl_b32 s68, s0, 7
    s_add_u32 s87, s87, s68
    s_lshl_b32 s0, s0, 2
    s_add_u32 s0, s0, s45
    s_mul_i32 s0, s0, 48
    s_mul_i32 s1, s1, 6
    s_add_u32 s0, s0, s1
    s_add_u32 s0, s0, s44
    s_lshl_b32 s0, s0, 10
    s_add_u32 s88, s0, 4194304
    s_mov_b32 s62, 0x7f000000
    s_cmp_eq_u32 s44, 0
    s_mov_b32 s68, 0x3c383430
    s_cselect_b32 s80, 0x0c080400, s68
    s_mov_b32 s68, 0x4c484440
    s_cselect_b32 s81, 0x1c181410, s68
    s_mov_b32 s68, 0x9c989490
    s_cselect_b32 s82, 0x6c686460, s68
    s_mov_b32 s68, 0xaca8a4a0
    s_cselect_b32 s83, 0x7c787470, s68
    s_mov_b32 s68, 0xb8b08880
    s_cselect_b32 s84, 0x58502820, s68
    s_mov_b32 s68, 0xbcb48c84
    s_cselect_b32 s85, 0x5c542c24, s68
    s_branch L_t_1_j
L_t_1_wo:
    s_mov_b32 s20, s56
    s_mov_b32 s21, s57
    s_mov_b32 s22, 819200
    s_mov_b32 s23, 0x00020000
    s_sub_u32 s0, s43, 176
    s_mul_i32 s1, s0, 6554
    s_lshr_b32 s1, s1, 16
    s_mul_i32 s68, s1, 10
    s_sub_u32 s0, s0, s68
    s_mov_b32 s86, 1280
    s_mov_b32 s89, 5
    s_mul_i32 s87, s1, 204800
    s_lshl_b32 s68, s0, 7
    s_add_u32 s87, s87, s68
    s_lshl_b32 s0, s0, 2
    s_add_u32 s0, s0, s45
    s_mul_i32 s0, s0, 20
    s_mul_i32 s1, s1, 5
    s_add_u32 s0, s0, s1
    s_add_u32 s0, s0, s44
    s_lshl_b32 s0, s0, 10
    s_add_u32 s88, s0, 1048576
    s_mov_b32 s62, 0x7f000000
    s_cmp_eq_u32 s44, 0
    s_mov_b32 s68, 0x403c2c28
    s_cselect_b32 s80, 0x18140400, s68
    s_mov_b32 s68, 0x48443430
    s_cselect_b32 s81, 0x201c0c08, s68
    s_mov_b32 s68, 0x908c7c78
    s_cselect_b32 s82, 0x68645450, s68
    s_mov_b32 s68, 0x98948480
    s_cselect_b32 s83, 0x706c5c58, s68
    s_mov_b32 s68, 0x00000000
    s_cselect_b32 s84, 0x88603810, s68
    s_mov_b32 s68, 0x00000000
    s_cselect_b32 s85, 0x9c744c24, s68
L_t_1_j:
    s_cmp_ge_u32 s43, 216
    s_cselect_b32 s88, 0x7f000000, s88
    s_add_u32 s0, s44, 4
    s_add_u32 s1, s88, 4096
    s_cmp_ge_u32 s0, s89
    s_cselect_b32 s89, 0x7f000000, s1
    s_lshr_b32 s43, s45, 1
    s_and_b32 s63, s38, 1
    s_lshl_b32 s0, s44, 1
    s_add_u32 s63, s63, s0
    s_lshl_b32 s0, s36, 2
    s_add_u32 s0, s0, s63
    s_mul_i32 s0, s0, 20480
    s_mul_i32 s1, s37, 160
    s_add_u32 s67, s0, s1
    s_lshl_b32 s0, s5, 7
    s_lshl_b32 s1, s38, 3
    s_add_u32 s0, s0, s1
    s_add_u32 s3, s0, 65536
    s_mul_i32 s6, s36, 196608
    s_add_u32 s6, s6, 6389760
    s_mul_i32 s0, s37, 240
    s_mul_i32 s1, s38, 6
    s_add_u32 s0, s0, s1
    s_lshl_b32 s0, s0, 10
    s_add_u32 s7, s0, 4194304
    s_add_u32 s70, s44, s39
    s_cmp_eq_u32 s70, 0
    s_cbranch_scc1 L_nojobA
    s_add_u32 m0, s74, 0
    s_nop 0
    buffer_load_dwordx4 v77, s[8:11], s72 offen offset:0 lds
    s_add_u32 m0, s74, 768
    s_nop 0
    buffer_load_dwordx4 v77, s[8:11], s72 offen offset:256 lds
    s_add_u32 m0, s74, 1536
    s_nop 0
    buffer_load_dwordx4 v77, s[8:11], s72 offen offset:512 lds
    s_add_u32 m0, s74, 2304
    s_nop 0
    buffer_load_dwordx4 v77, s[8:11], s72 offen offset:768 lds
    s_add_u32 m0, s74, 3072
    s_nop 0
    buffer_load_dwordx4 v77, s[8:11], s72 offen offset:1024 lds
    s_add_u32 m0, s74, 5120
    s_nop 0
    buffer_load_dwordx4 v78, s[8:11], s72 offen offset:0 lds
    s_add_u32 m0, s74, 5888
    s_nop 0
    buffer_load_dwordx4 v78, s[8:11], s72 offen offset:256 lds
    s_cmp_eq_u32 s44, 0
    s_cbranch_scc1 L_teamA
    s_add_u32 m0, s74, 6656
    s_nop 0
    buffer_load_dwordx4 v78, s[8:11], s72 offen offset:512 lds
    s_add_u32 m0, s74, 7424
    s_nop 0
    buffer_load_dwordx4 v78, s[8:11], s72 offen offset:768 lds
    s_add_u32 m0, s74, 8192
    s_nop 0
    buffer_load_dwordx4 v78, s[8:11], s72 offen offset:1024 lds
    s_add_u32 s70, s69, 0
    s_cmp_ge_u32 s70, 5
    s_cselect_b32 s71, 5, 0
    s_sub_u32 s70, s70, s71
    s_mul_i32 s70, s70, 163840
    s_add_u32 s70, s70, s75
    s_add_u32 s71, s70, 20480
    s_add_u32 m0, s73, 106496
    s_nop 0
    buffer_load_dwordx4 v72, s[12:15], s70 offen lds
    s_add_u32 m0, s73, 107520
    s_nop 0
    buffer_load_dwordx4 v73, s[12:15], s70 offen lds
    s_add_u32 m0, s73, 108544
    s_nop 0
    buffer_load_dwordx4 v74, s[12:15], s70 offen lds
    s_add_u32 m0, s73, 109568
    s_nop 0
    buffer_load_dwordx4 v72, s[12:15], s71 offen lds
    s_add_u32 m0, s73, 110592
    s_nop 0
    buffer_load_dwordx4 v73, s[12:15], s71 offen lds
    s_add_u32 m0, s73, 111616
    s_nop 0
    buffer_load_dwordx4 v74, s[12:15], s71 offen lds
    s_branch L_nojobA
L_teamA:
    v_mov_b32 v112, s42
    v_mov_b32 v113, s42
    v_mov_b32 v114, s42
    v_mov_b32 v115, s42
    s_waitcnt vmcnt(10)
    ds_read_b64_tr_b16 a[48:49], v89 offset:0
    ds_read_b64_tr_b16 a[50:51], v89 offset:160
    ds_read_b64_tr_b16 a[52:53], v89 offset:640
    ds_read_b64_tr_b16 a[54:55], v89 offset:800
    ds_read_b64_tr_b16 a[56:57], v89 offset:1280
    ds_read_b64_tr_b16 a[58:59], v89 offset:1440
    ds_read_b64_tr_b16 a[60:61], v89 offset:1920
    ds_read_b64_tr_b16 a[62:63], v89 offset:2080
    ds_read_b64_tr_b16 a[64:65], v89 offset:2560
    ds_read_b64_tr_b16 a[66:67], v89 offset:2720
    ds_read_b64_tr_b16 a[68:69], v89 offset:3200
    ds_read_b64_tr_b16 a[70:71], v89 offset:3360
    ds_read_b64_tr_b16 a[72:73], v89 offset:3840
    ds_read_b64_tr_b16 a[74:75], v89 offset:4000
    ds_read_b64_tr_b16 a[76:77], v89 offset:4480
    ds_read_b64_tr_b16 a[78:79], v89 offset:4640
    ds_read_b64_tr_b16 a[80:81], v89 offset:5120
    ds_read_b64_tr_b16 a[82:83], v89 offset:5280
    ds_read_b64_tr_b16 a[84:85], v89 offset:5760
    ds_read_b64_tr_b16 a[86:87], v89 offset:5920
    s_lshr_b32 s70, s37, 1
    s_mul_i32 s72, s70, 40960
    s_mul_i32 s71, s38, 320
    s_lshl_b32 s70, s70, 7
    s_add_u32 s70, s70, 160000
    v_add_u32 v19, s72, v94
    s_waitcnt lgkmcnt(0)
    s_bitcmp1_b32 s37, 0
    s_cbranch_scc1 L_csV
    v_and_b32 v18, 31, v0
    v_lshlrev_b32 v18, 2, v18
    v_add_u32 v18, s70, v18
    v_mfma_f32_32x32x16_bf16 v[96:111], a[48:51], v[112:115], 0
    s_and_b32 s70, s71, 255
    v_xor_b32 v8, s70, v19
    s_andn2_b32 s70, s71, 255
    v_lshl_add_u32 v8, s70, 2, v8
    s_add_u32 s71, s71, 32
    v_mfma_f32_32x32x16_bf16 v[96:111], a[52:55], v[112:115], v[96:111]
    s_and_b32 s70, s71, 255
    v_xor_b32 v9, s70, v19
    s_andn2_b32 s70, s71, 255
    v_lshl_add_u32 v9, s70, 2, v9
    s_add_u32 s71, s71, 32
    v_mfma_f32_32x32x16_bf16 v[96:111], a[56:59], v[112:115], v[96:111]
    s_and_b32 s70, s71, 255
    v_xor_b32 v10, s70, v19
    s_andn2_b32 s70, s71, 255
    v_lshl_add_u32 v10, s70, 2, v10
    s_add_u32 s71, s71, 32
    v_mfma_f32_32x32x16_bf16 v[96:111], a[60:63], v[112:115], v[96:111]
    s_and_b32 s70, s71, 255
    v_xor_b32 v11, s70, v19
    s_andn2_b32 s70, s71, 255
    v_lshl_add_u32 v11, s70, 2, v11
    s_add_u32 s71, s71, 32
    v_mfma_f32_32x32x16_bf16 v[96:111], a[64:67], v[112:115], v[96:111]
    s_and_b32 s70, s71, 255
    v_xor_b32 v12, s70, v19
    s_andn2_b32 s70, s71, 255
    v_lshl_add_u32 v12, s70, 2, v12
    s_add_u32 s71, s71, 32
    v_mfma_f32_32x32x16_bf16 v[96:111], a[68:71], v[112:115], v[96:111]
    s_and_b32 s70, s71, 255
    v_xor_b32 v13, s70, v19
    s_andn2_b32 s70, s71, 255
    v_lshl_add_u32 v13, s70, 2, v13
    s_add_u32 s71, s71, 32
    v_mfma_f32_32x32x16_bf16 v[96:111], a[72:75], v[112:115], v[96:111]
    s_and_b32 s70, s71, 255
    v_xor_b32 v14, s70, v19
    s_andn2_b32 s70, s71, 255
    v_lshl_add_u32 v14, s70, 2, v14
    s_add_u32 s71, s71, 32
    v_mfma_f32_32x32x16_bf16 v[96:111], a[76:79], v[112:115], v[96:111]
    s_and_b32 s70, s71, 255
    v_xor_b32 v15, s70, v19
    s_andn2_b32 s70, s71, 255
    v_lshl_add_u32 v15, s70, 2, v15
    s_add_u32 s71, s71, 32
    v_mfma_f32_32x32x16_bf16 v[96:111], a[80:83], v[112:115], v[96:111]
    s_and_b32 s70, s71, 255
    v_xor_b32 v16, s70, v19
    s_andn2_b32 s70, s71, 255
    v_lshl_add_u32 v16, s70, 2, v16
    s_add_u32 s71, s71, 32
    v_mfma_f32_32x32x16_bf16 v[96:111], a[84:87], v[112:115], v[96:111]
    s_and_b32 s70, s71, 255
    v_xor_b32 v17, s70, v19
    s_andn2_b32 s70, s71, 255
    v_lshl_add_u32 v17, s70, 2, v17
    s_add_u32 s71, s71, 32
    s_branch L_nojobA
L_csV:
    v_lshrrev_b32 v18, 5, v0
    v_lshlrev_b32 v18, 4, v18
    v_add_u32 v18, s70, v18
    v_mfma_f32_32x32x16_bf16 v[96:111], v[112:115], a[48:51], 0
    s_and_b32 s70, s71, 255
    v_xor_b32 v8, s70, v19
    s_andn2_b32 s70, s71, 255
    v_lshl_add_u32 v8, s70, 2, v8
    s_add_u32 s71, s71, 32
    v_mfma_f32_32x32x16_bf16 v[96:111], v[112:115], a[52:55], v[96:111]
    s_and_b32 s70, s71, 255
    v_xor_b32 v9, s70, v19
    s_andn2_b32 s70, s71, 255
    v_lshl_add_u32 v9, s70, 2, v9
    s_add_u32 s71, s71, 32
    v_mfma_f32_32x32x16_bf16 v[96:111], v[112:115], a[56:59], v[96:111]
    s_and_b32 s70, s71, 255
    v_xor_b32 v10, s70, v19
    s_andn2_b32 s70, s71, 255
    v_lshl_add_u32 v10, s70, 2, v10
    s_add_u32 s71, s71, 32
    v_mfma_f32_32x32x16_bf16 v[96:111], v[112:115], a[60:63], v[96:111]
    s_and_b32 s70, s71, 255
    v_xor_b32 v11, s70, v19
    s_andn2_b32 s70, s71, 255
    v_lshl_add_u32 v11, s70, 2, v11
    s_add_u32 s71, s71, 32
    v_mfma_f32_32x32x16_bf16 v[96:111], v[112:115], a[64:67], v[96:111]
    s_and_b32 s70, s71, 255
    v_xor_b32 v12, s70, v19
    s_andn2_b32 s70, s71, 255
    v_lshl_add_u32 v12, s70, 2, v12
    s_add_u32 s71, s71, 32
    v_mfma_f32_32x32x16_bf16 v[96:111], v[112:115], a[68:71], v[96:111]
    s_and_b32 s70, s71, 255
    v_xor_b32 v13, s70, v19
    s_andn2_b32 s70, s71, 255
    v_lshl_add_u32 v13, s70, 2, v13
    s_add_u32 s71, s71, 32
    v_mfma_f32_32x32x16_bf16 v[96:111], v[112:115], a[72:75], v[96:111]
    s_and_b32 s70, s71, 255
    v_xor_b32 v14, s70, v19
    s_andn2_b32 s70, s71, 255
    v_lshl_add_u32 v14, s70, 2, v14
    s_add_u32 s71, s71, 32
    v_mfma_f32_32x32x16_bf16 v[96:111], v[112:115], a[76:79], v[96:111]
    s_and_b32 s70, s71, 255
    v_xor_b32 v15, s70, v19
    s_andn2_b32 s70, s71, 255
    v_lshl_add_u32 v15, s70, 2, v15
    s_add_u32 s71, s71, 32
    v_mfma_f32_32x32x16_bf16 v[96:111], v[112:115], a[80:83], v[96:111]
    s_and_b32 s70, s71, 255
    v_xor_b32 v16, s70, v19
    s_andn2_b32 s70, s71, 255
    v_lshl_add_u32 v16, s70, 2, v16
    s_add_u32 s71, s71, 32
    v_mfma_f32_32x32x16_bf16 v[96:111], v[112:115], a[84:87], v[96:111]
    s_and_b32 s70, s71, 255
    v_xor_b32 v17, s70, v19
    s_andn2_b32 s70, s71, 255
    v_lshl_add_u32 v17, s70, 2, v17
    s_add_u32 s71, s71, 32
L_nojobA:
    v_add_u32 v88, s74, v1
    v_mov_b32 v80, 0
    v_mov_b32 v81, 0
    v_mov_b32 v82, 0
    v_mov_b32 v83, 0
    v_mov_b32 v84, 0
    v_mov_b32 v85, 0
    v_mov_b32 v86, 0
    v_mov_b32 v87, 0
    s_waitcnt vmcnt(6)
    s_cmp_lg_u32 s44, 0
    s_cbranch_scc1 L_tm_2
    s_waitcnt vmcnt(0)
L_tm_2:
    ds_read_b128 v[32:35], v88 offset:0
    ds_read_b128 v[36:39], v88 offset:1024
    ds_read_b128 v[40:43], v88 offset:2048
    ds_read_b128 v[44:47], v88 offset:3072
    ds_read_b128 v[48:51], v88 offset:4096
    ds_read_b128 v[52:55], v88 offset:5120
    ds_read_b128 v[56:59], v88 offset:6144
    ds_read_b128 v[60:63], v88 offset:7168
    ds_read_b128 v[64:67], v88 offset:8192
    ds_read_b128 v[68:71], v88 offset:9216
    s_waitcnt lgkmcnt(9)
    v_dot2c_f32_bf16 v80, s42, v32
    v_dot2c_f32_bf16 v82, v32, v32
    v_dot2c_f32_bf16 v81, s42, v33
    v_dot2c_f32_bf16 v83, v33, v33
    v_dot2c_f32_bf16 v80, s42, v34
    v_dot2c_f32_bf16 v82, v34, v34
    v_dot2c_f32_bf16 v81, s42, v35
    v_dot2c_f32_bf16 v83, v35, v35
    s_waitcnt lgkmcnt(7)
    v_dot2c_f32_bf16 v80, s42, v36
    v_dot2c_f32_bf16 v82, v36, v36
    v_dot2c_f32_bf16 v81, s42, v37
    v_dot2c_f32_bf16 v83, v37, v37
    v_dot2c_f32_bf16 v80, s42, v38
    v_dot2c_f32_bf16 v82, v38, v38
    v_dot2c_f32_bf16 v81, s42, v39
    v_dot2c_f32_bf16 v83, v39, v39
    v_dot2c_f32_bf16 v80, s42, v40
    v_dot2c_f32_bf16 v82, v40, v40
    v_dot2c_f32_bf16 v81, s42, v41
    v_dot2c_f32_bf16 v83, v41, v41
    v_dot2c_f32_bf16 v80, s42, v42
    v_dot2c_f32_bf16 v82, v42, v42
    v_dot2c_f32_bf16 v81, s42, v43
    v_dot2c_f32_bf16 v83, v43, v43
    s_waitcnt lgkmcnt(4)
    v_dot2c_f32_bf16 v80, s42, v44
    v_dot2c_f32_bf16 v82, v44, v44
    v_dot2c_f32_bf16 v81, s42, v45
    v_dot2c_f32_bf16 v83, v45, v45
    v_dot2c_f32_bf16 v80, s42, v46
    v_dot2c_f32_bf16 v82, v46, v46
    v_dot2c_f32_bf16 v81, s42, v47
    v_dot2c_f32_bf16 v83, v47, v47
    v_dot2c_f32_bf16 v80, s42, v48
    v_dot2c_f32_bf16 v82, v48, v48
    v_dot2c_f32_bf16 v81, s42, v49
    v_dot2c_f32_bf16 v83, v49, v49
    v_dot2c_f32_bf16 v80, s42, v50
    v_dot2c_f32_bf16 v82, v50, v50
    v_dot2c_f32_bf16 v81, s42, v51
    v_dot2c_f32_bf16 v83, v51, v51
    v_dot2c_f32_bf16 v84, s42, v52
    v_dot2c_f32_bf16 v86, v52, v52
    v_dot2c_f32_bf16 v85, s42, v53
    v_dot2c_f32_bf16 v87, v53, v53
    v_dot2c_f32_bf16 v84, s42, v54
    v_dot2c_f32_bf16 v86, v54, v54
    v_dot2c_f32_bf16 v85, s42, v55
    v_dot2c_f32_bf16 v87, v55, v55
    s_waitcnt lgkmcnt(0)
    v_dot2c_f32_bf16 v84, s42, v56
    v_dot2c_f32_bf16 v86, v56, v56
    v_dot2c_f32_bf16 v85, s42, v57
    v_dot2c_f32_bf16 v87, v57, v57
    v_dot2c_f32_bf16 v84, s42, v58
    v_dot2c_f32_bf16 v86, v58, v58
    v_dot2c_f32_bf16 v85, s42, v59
    v_dot2c_f32_bf16 v87, v59, v59
    v_dot2c_f32_bf16 v84, s42, v60
    v_dot2c_f32_bf16 v86, v60, v60
    v_dot2c_f32_bf16 v85, s42, v61
    v_dot2c_f32_bf16 v87, v61, v61
    v_dot2c_f32_bf16 v84, s42, v62
    v_dot2c_f32_bf16 v86, v62, v62
    v_dot2c_f32_bf16 v85, s42, v63
    v_dot2c_f32_bf16 v87, v63, v63
    v_dot2c_f32_bf16 v84, s42, v64
    v_dot2c_f32_bf16 v86, v64, v64
    v_dot2c_f32_bf16 v85, s42, v65
    v_dot2c_f32_bf16 v87, v65, v65
    v_dot2c_f32_bf16 v84, s42, v66
    v_dot2c_f32_bf16 v86, v66, v66
    v_dot2c_f32_bf16 v85, s42, v67
    v_dot2c_f32_bf16 v87, v67, v67
    v_dot2c_f32_bf16 v84, s42, v68
    v_dot2c_f32_bf16 v86, v68, v68
    v_dot2c_f32_bf16 v85, s42, v69
    v_dot2c_f32_bf16 v87, v69, v69
    v_dot2c_f32_bf16 v84, s42, v70
    v_dot2c_f32_bf16 v86, v70, v70
    v_dot2c_f32_bf16 v85, s42, v71
    v_dot2c_f32_bf16 v87, v71, v71
    v_add_f32 v80, v80, v81
    v_add_f32 v82, v82, v83
    v_add_f32 v84, v84, v85
    v_add_f32 v86, v86, v87
    v_add_f32_dpp v80, v80, v80 row_ror:8 row_mask:0xf bank_mask:0xf
    v_add_f32_dpp v82, v82, v82 row_ror:8 row_mask:0xf bank_mask:0xf
    v_add_f32_dpp v84, v84, v84 row_ror:8 row_mask:0xf bank_mask:0xf
    v_add_f32_dpp v86, v86, v86 row_ror:8 row_mask:0xf bank_mask:0xf
    v_add_f32_dpp v80, v80, v80 row_ror:4 row_mask:0xf bank_mask:0xf
    v_add_f32_dpp v82, v82, v82 row_ror:4 row_mask:0xf bank_mask:0xf
    v_add_f32_dpp v84, v84, v84 row_ror:4 row_mask:0xf bank_mask:0xf
    v_add_f32_dpp v86, v86, v86 row_ror:4 row_mask:0xf bank_mask:0xf
    v_add_f32_dpp v80, v80, v80 row_ror:2 row_mask:0xf bank_mask:0xf
    v_add_f32_dpp v82, v82, v82 row_ror:2 row_mask:0xf bank_mask:0xf
    v_add_f32_dpp v84, v84, v84 row_ror:2 row_mask:0xf bank_mask:0xf
    v_add_f32_dpp v86, v86, v86 row_ror:2 row_mask:0xf bank_mask:0xf
    v_add_f32_dpp v80, v80, v80 row_ror:1 row_mask:0xf bank_mask:0xf
    v_add_f32_dpp v82, v82, v82 row_ror:1 row_mask:0xf bank_mask:0xf
    v_add_f32_dpp v84, v84, v84 row_ror:1 row_mask:0xf bank_mask:0xf
    v_add_f32_dpp v86, v86, v86 row_ror:1 row_mask:0xf bank_mask:0xf
    v_mul_f32 v80, 0xbacccccd, v80
    v_mul_f32 v84, 0xbacccccd, v84
    v_mul_f32 v82, 0x3acccccd, v82
    v_mul_f32 v86, 0x3acccccd, v86
    ds_write_b32 v79, v80
    ds_write_b32 v79, v84 offset:16
    v_fma_f32 v82, -v80, v80, v82
    v_fma_f32 v86, -v84, v84, v86
    v_max_f32 v82, 0, v82
    v_max_f32 v86, 0, v86
    v_add_f32 v82, 0x3727c5ac, v82
    v_add_f32 v86, 0x3727c5ac, v86
    v_rsq_f32 v82, v82
    v_rsq_f32 v86, v86
    s_nop 0
    ds_write_b32 v79, v82 offset:256
    ds_write_b32 v79, v86 offset:272
    s_cmp_lg_u32 s39, 0
    s_cbranch_scc1 L_jobB
    s_lshl_b32 s70, s44, 5
    v_xor_b32 v94, s70, v94
    v_lshl_add_u32 v94, s69, 10, v94
    s_mul_i32 s70, s44, 40960
    s_sub_u32 s71, 40960, s70
    v_add_u32 v56, s70, v94
    v_add_u32 v60, s71, v94
    v_xor_b32 v57, 64, v56
    v_xor_b32 v61, 64, v60
    v_xor_b32 v58, 128, v56
    v_xor_b32 v62, 128, v60
    v_xor_b32 v59, 192, v56
    v_xor_b32 v63, 192, v60
    s_mul_i32 s70, s45, 40
    v_add_u32 v95, s70, v93
    v_and_b32 v75, 19, v0
    v_cmp_lt_u32 vcc, 16, v75
    s_mul_i32 s71, s44, 3072
    s_add_u32 s71, s71, 81920
    s_lshl_b32 s70, s45, 3
    s_lshr_b32 s70, 0xa0b8a0a8, s70
    s_and_b32 s70, s70, 255
    v_mov_b32 v75, s70
    v_cndmask_b32 v95, v95, v75, vcc
    v_mul_u32_u24 v75, 192, v92
    v_add3_u32 v95, v95, v75, s71
    v_add_u32 v75, 49152, v95
    buffer_load_dwordx2 v[90:91], off, s[28:31], 0 sc1
    s_cmp_eq_u32 s44, 0
    s_cbranch_scc1 L_jobdone
    s_add_u32 s70, s69, 1
    s_cmp_ge_u32 s70, 5
    s_cselect_b32 s71, 5, 0
    s_sub_u32 s70, s70, s71
    s_mul_i32 s70, s70, 163840
    s_add_u32 s70, s70, s75
    s_add_u32 s71, s70, 20480
    s_add_u32 m0, s73, 81920
    s_nop 0
    buffer_load_dwordx4 v72, s[12:15], s70 offen lds
    s_add_u32 m0, s73, 82944
    s_nop 0
    buffer_load_dwordx4 v73, s[12:15], s70 offen lds
    s_add_u32 m0, s73, 83968
    s_nop 0
    buffer_load_dwordx4 v74, s[12:15], s70 offen lds
    s_add_u32 m0, s73, 84992
    s_nop 0
    buffer_load_dwordx4 v72, s[12:15], s71 offen lds
    s_add_u32 m0, s73, 86016
    s_nop 0
    buffer_load_dwordx4 v73, s[12:15], s71 offen lds
    s_add_u32 m0, s73, 87040
    s_nop 0
    buffer_load_dwordx4 v74, s[12:15], s71 offen lds
    s_waitcnt vmcnt(7)
    s_branch L_a2
L_jobB:
    buffer_load_dwordx2 v[90:91], off, s[28:31], 0 sc1
    v_mov_b32 v88, 159872
    v_mov_b32 v89, 1
    s_mov_b64 exec, 1
    ds_add_u32 v88, v89
    s_mov_b64 exec, -1
    s_mul_i32 s70, s38, 7168
    s_add_u32 s70, s70, 131072
    v_add_u32 v86, s70, v1
    s_mov_b32 s79, 0x200000
L_lw_3:
    ds_read_b32 v87, v88 offset:0
    s_sub_u32 s79, s79, 1
    s_cbranch_scc1 L_lw_3_d
    s_waitcnt lgkmcnt(0)
    v_cmp_gt_u32 vcc, 4, v87
    s_cbranch_vccnz L_lw_3
L_lw_3_d:
    s_bitcmp1_b32 s37, 0
    s_cbranch_scc1 L_jobV
    ds_read_b32 v112, v18
    ds_read_b32 v113, v18 offset:256
    ds_read_b128 a[0:3], v8
    ds_read_b128 a[4:7], v9
    ds_read_b128 a[8:11], v10
    ds_read_b128 a[12:15], v11
    ds_read_b128 a[16:19], v12
    ds_read_b128 a[20:23], v13
    ds_read_b128 a[24:27], v14
    ds_read_b128 a[28:31], v15
    ds_read_b128 a[32:35], v16
    ds_read_b128 a[36:39], v17
    s_waitcnt lgkmcnt(10)
    v_pk_mul_f32 v[96:97], v[96:97], v[112:113] op_sel_hi:[1,0]
    v_pk_mul_f32 v[98:99], v[98:99], v[112:113] op_sel_hi:[1,0]
    v_pk_mul_f32 v[100:101], v[100:101], v[112:113] op_sel_hi:[1,0]
    v_pk_mul_f32 v[102:103], v[102:103], v[112:113] op_sel_hi:[1,0]
    v_pk_mul_f32 v[104:105], v[104:105], v[112:113] op_sel_hi:[1,0]
    v_pk_mul_f32 v[106:107], v[106:107], v[112:113] op_sel_hi:[1,0]
    v_pk_mul_f32 v[108:109], v[108:109], v[112:113] op_sel_hi:[1,0]
    v_pk_mul_f32 v[110:111], v[110:111], v[112:113] op_sel_hi:[1,0]
    s_waitcnt lgkmcnt(9)
    s_nop 0
    v_mfma_f32_32x32x16_bf16 v[96:111], a[48:51], a[0:3], v[96:111]
    s_waitcnt lgkmcnt(8)
    v_mfma_f32_32x32x16_bf16 v[96:111], a[52:55], a[4:7], v[96:111]
    s_waitcnt lgkmcnt(7)
    v_mfma_f32_32x32x16_bf16 v[96:111], a[56:59], a[8:11], v[96:111]
    s_waitcnt lgkmcnt(6)
    v_mfma_f32_32x32x16_bf16 v[96:111], a[60:63], a[12:15], v[96:111]
    s_waitcnt lgkmcnt(5)
    v_mfma_f32_32x32x16_bf16 v[96:111], a[64:67], a[16:19], v[96:111]
    s_waitcnt lgkmcnt(4)
    v_mfma_f32_32x32x16_bf16 v[96:111], a[68:71], a[20:23], v[96:111]
    s_waitcnt lgkmcnt(3)
    v_mfma_f32_32x32x16_bf16 v[96:111], a[72:75], a[24:27], v[96:111]
    s_waitcnt lgkmcnt(2)
    v_mfma_f32_32x32x16_bf16 v[96:111], a[76:79], a[28:31], v[96:111]
    s_waitcnt lgkmcnt(1)
    v_mfma_f32_32x32x16_bf16 v[96:111], a[80:83], a[32:35], v[96:111]
    s_waitcnt lgkmcnt(0)
    v_mfma_f32_32x32x16_bf16 v[96:111], a[84:87], a[36:39], v[96:111]
    s_branch L_jobW
L_jobV:
    ds_read_b128 v[112:115], v18 offset:0
    ds_read_b128 v[116:119], v18 offset:32
    ds_read_b128 v[120:123], v18 offset:64
    ds_read_b128 v[124:127], v18 offset:96
    ds_read_b128 a[0:3], v8
    ds_read_b128 a[4:7], v9
    ds_read_b128 a[8:11], v10
    ds_read_b128 a[12:15], v11
    ds_read_b128 a[16:19], v12
    ds_read_b128 a[20:23], v13
    ds_read_b128 a[24:27], v14
    ds_read_b128 a[28:31], v15
    ds_read_b128 a[32:35], v16
    ds_read_b128 a[36:39], v17
    s_waitcnt lgkmcnt(10)
    v_pk_mul_f32 v[96:97], v[96:97], v[112:113]
    v_pk_mul_f32 v[98:99], v[98:99], v[114:115]
    v_pk_mul_f32 v[100:101], v[100:101], v[116:117]
    v_pk_mul_f32 v[102:103], v[102:103], v[118:119]
    v_pk_mul_f32 v[104:105], v[104:105], v[120:121]
    v_pk_mul_f32 v[106:107], v[106:107], v[122:123]
    v_pk_mul_f32 v[108:109], v[108:109], v[124:125]
    v_pk_mul_f32 v[110:111], v[110:111], v[126:127]
    s_waitcnt lgkmcnt(9)
    s_nop 0
    v_mfma_f32_32x32x16_bf16 v[96:111], a[0:3], a[48:51], v[96:111]
    s_waitcnt lgkmcnt(8)
    v_mfma_f32_32x32x16_bf16 v[96:111], a[4:7], a[52:55], v[96:111]
    s_waitcnt lgkmcnt(7)
    v_mfma_f32_32x32x16_bf16 v[96:111], a[8:11], a[56:59], v[96:111]
    s_waitcnt lgkmcnt(6)
    v_mfma_f32_32x32x16_bf16 v[96:111], a[12:15], a[60:63], v[96:111]
    s_waitcnt lgkmcnt(5)
    v_mfma_f32_32x32x16_bf16 v[96:111], a[16:19], a[64:67], v[96:111]
    s_waitcnt lgkmcnt(4)
    v_mfma_f32_32x32x16_bf16 v[96:111], a[20:23], a[68:71], v[96:111]
    s_waitcnt lgkmcnt(3)
    v_mfma_f32_32x32x16_bf16 v[96:111], a[24:27], a[72:75], v[96:111]
    s_waitcnt lgkmcnt(2)
    v_mfma_f32_32x32x16_bf16 v[96:111], a[28:31], a[76:79], v[96:111]
    s_waitcnt lgkmcnt(1)
    v_mfma_f32_32x32x16_bf16 v[96:111], a[32:35], a[80:83], v[96:111]
    s_waitcnt lgkmcnt(0)
    v_mfma_f32_32x32x16_bf16 v[96:111], a[36:39], a[84:87], v[96:111]
    ds_read_b128 v[112:115], v18 offset:256
    ds_read_b128 v[116:119], v18 offset:288
    ds_read_b128 v[120:123], v18 offset:320
    ds_read_b128 v[124:127], v18 offset:352
L_jobW:
    s_cmp_eq_u32 s38, 0
    s_cselect_b32 s39, 3, 2
    s_cbranch_scc1 L_fin0
    s_nop 7
    ds_write_b128 v86, v[96:99] offset:0
    ds_write_b128 v86, v[100:103] offset:1024
    ds_write_b128 v86, v[104:107] offset:2048
    ds_write_b128 v86, v[108:111] offset:3072
    s_mov_b64 exec, 1
    ds_add_u32 v88, v89 offset:4
    s_mov_b64 exec, -1
L_fin0:
    s_lshl_b32 s70, s44, 5
    v_xor_b32 v94, s70, v94
    v_lshl_add_u32 v94, s69, 10, v94
    s_mul_i32 s70, s44, 40960
    s_sub_u32 s71, 40960, s70
    v_add_u32 v56, s70, v94
    v_add_u32 v60, s71, v94
    v_xor_b32 v57, 64, v56
    v_xor_b32 v61, 64, v60
    v_xor_b32 v58, 128, v56
    v_xor_b32 v62, 128, v60
    v_xor_b32 v59, 192, v56
    v_xor_b32 v63, 192, v60
    s_mul_i32 s70, s45, 40
    v_add_u32 v95, s70, v93
    v_and_b32 v75, 19, v0
    v_cmp_lt_u32 vcc, 16, v75
    s_mul_i32 s71, s44, 3072
    s_add_u32 s71, s71, 81920
    s_lshl_b32 s70, s45, 3
    s_lshr_b32 s70, 0xa0b8a0a8, s70
    s_and_b32 s70, s70, 255
    v_mov_b32 v75, s70
    v_cndmask_b32 v95, v95, v75, vcc
    v_mul_u32_u24 v75, 192, v92
    v_add3_u32 v95, v95, v75, s71
    v_add_u32 v75, 49152, v95
    s_cmp_lg_u32 s39, 3
    s_cbranch_scc1 L_jobdone
    s_lshr_b32 s70, s37, 1
    s_lshl_b32 s71, s36, 1
    s_add_u32 s70, s70, s71
    s_mul_i32 s70, s70, 2688
    s_add_u32 s72, s70, 262144
    s_mov_b32 s79, 0x200000
L_lw_4:
    ds_read_b32 v87, v88 offset:4
    s_sub_u32 s79, s79, 1
    s_cbranch_scc1 L_lw_4_d
    s_waitcnt lgkmcnt(0)
    v_cmp_gt_u32 vcc, 3, v87
    s_cbranch_vccnz L_lw_4
L_lw_4_d:
    ds_read_b128 v[8:11], v86 offset:7168
    ds_read_b128 v[12:15], v86 offset:8192
    ds_read_b128 v[16:19], v86 offset:9216
    ds_read_b128 v[20:23], v86 offset:10240
    ds_read_b128 v[24:27], v86 offset:14336
    ds_read_b128 v[28:31], v86 offset:15360
    ds_read_b128 v[32:35], v86 offset:16384
    ds_read_b128 v[36:39], v86 offset:17408
    ds_read_b128 v[40:43], v86 offset:21504
    ds_read_b128 v[44:47], v86 offset:22528
    ds_read_b128 v[48:51], v86 offset:23552
    ds_read_b128 v[52:55], v86 offset:24576
    s_bitcmp1_b32 s37, 0
    s_cbranch_scc1 L_finV
    v_lshlrev_b32 v85, 3, v0
    s_waitcnt lgkmcnt(4)
    v_pk_add_f32 v[8:9], v[8:9], v[96:97]
    v_pk_add_f32 v[10:11], v[10:11], v[98:99]
    v_pk_add_f32 v[12:13], v[12:13], v[100:101]
    v_pk_add_f32 v[14:15], v[14:15], v[102:103]
    v_pk_add_f32 v[16:17], v[16:17], v[104:105]
    v_pk_add_f32 v[18:19], v[18:19], v[106:107]
    v_pk_add_f32 v[8:9], v[8:9], v[24:25]
    v_pk_add_f32 v[10:11], v[10:11], v[26:27]
    v_pk_add_f32 v[12:13], v[12:13], v[28:29]
    v_pk_add_f32 v[14:15], v[14:15], v[30:31]
    v_pk_add_f32 v[16:17], v[16:17], v[32:33]
    v_pk_add_f32 v[18:19], v[18:19], v[34:35]
    s_waitcnt lgkmcnt(0)
    v_pk_add_f32 v[8:9], v[8:9], v[40:41]
    v_pk_add_f32 v[10:11], v[10:11], v[42:43]
    v_pk_add_f32 v[12:13], v[12:13], v[44:45]
    v_pk_add_f32 v[14:15], v[14:15], v[46:47]
    v_pk_add_f32 v[16:17], v[16:17], v[48:49]
    v_pk_add_f32 v[18:19], v[18:19], v[50:51]
    v_pk_mul_f32 v[8:9], v[8:9], v[112:113] op_sel:[0,1]
    v_pk_mul_f32 v[10:11], v[10:11], v[112:113] op_sel:[0,1]
    v_pk_mul_f32 v[12:13], v[12:13], v[112:113] op_sel:[0,1]
    v_pk_mul_f32 v[14:15], v[14:15], v[112:113] op_sel:[0,1]
    v_pk_mul_f32 v[16:17], v[16:17], v[112:113] op_sel:[0,1]
    v_pk_mul_f32 v[18:19], v[18:19], v[112:113] op_sel:[0,1]
    v_cvt_pk_bf16_f32 v64, v8, v9
    v_cvt_pk_bf16_f32 v65, v10, v11
    v_cvt_pk_bf16_f32 v66, v12, v13
    v_cvt_pk_bf16_f32 v67, v14, v15
    v_cvt_pk_bf16_f32 v68, v16, v17
    v_cvt_pk_bf16_f32 v69, v18, v19
    buffer_store_dwordx4 v[64:67], v1, s[32:35], s72 offen sc1
    s_mov_b32 exec_hi, 0
    buffer_store_dwordx2 v[68:69], v85, s[32:35], s72 offen offset:1024 sc1
    s_mov_b64 exec, -1
    v_pk_mul_f32 v[32:33], v[8:9], v[8:9]
    v_pk_mul_f32 v[34:35], v[16:17], v[16:17]
    v_pk_fma_f32 v[32:33], v[10:11], v[10:11], v[32:33]
    v_pk_fma_f32 v[34:35], v[18:19], v[18:19], v[34:35]
    v_pk_fma_f32 v[32:33], v[12:13], v[12:13], v[32:33]
    v_pk_fma_f32 v[32:33], v[14:15], v[14:15], v[32:33]
    v_add_f32 v34, v34, v35
    v_add_f32 v122, v32, v33
    v_cndmask_b32 v34, 0, v34, s[90:91]
    v_add_f32 v122, v122, v34
    v_mov_b32 v32, v122
    s_nop 1
    v_permlane32_swap_b32 v122, v32
    v_add_f32 v122, v122, v32
    s_nop 1
    v_max_f32_dpp v122, v122, v122 row_ror:8 row_mask:0xf bank_mask:0xf
    s_nop 1
    v_max_f32_dpp v122, v122, v122 row_ror:4 row_mask:0xf bank_mask:0xf
    s_nop 1
    v_max_f32_dpp v122, v122, v122 row_ror:2 row_mask:0xf bank_mask:0xf
    s_nop 1
    v_max_f32_dpp v122, v122, v122 row_ror:1 row_mask:0xf bank_mask:0xf
    v_mov_b32 v32, v122
    s_nop 1
    v_permlane16_swap_b32 v122, v32
    v_max_f32 v122, v122, v32
    s_branch L_jobdone
L_finV:
    v_and_b32 v84, 31, v0
    v_lshrrev_b32 v87, 5, v0
    v_mul_u32_u24 v87, 22, v87
    v_add_u32 v87, v87, v84
    v_lshlrev_b32 v87, 4, v87
    v_mov_b32 v89, s42
    v_cmp_eq_u32 vcc, 20, v84
    s_nop 1
    v_cndmask_b32 v89, 0, v89, vcc
    v_cmp_le_u32 vcc, 20, v84
    s_waitcnt lgkmcnt(4)
    v_pk_add_f32 v[8:9], v[8:9], v[96:97]
    v_pk_add_f32 v[10:11], v[10:11], v[98:99]
    v_pk_add_f32 v[12:13], v[12:13], v[100:101]
    v_pk_add_f32 v[14:15], v[14:15], v[102:103]
    v_pk_add_f32 v[16:17], v[16:17], v[104:105]
    v_pk_add_f32 v[18:19], v[18:19], v[106:107]
    v_pk_add_f32 v[20:21], v[20:21], v[108:109]
    v_pk_add_f32 v[22:23], v[22:23], v[110:111]
    v_pk_add_f32 v[8:9], v[8:9], v[24:25]
    v_pk_add_f32 v[10:11], v[10:11], v[26:27]
    v_pk_add_f32 v[12:13], v[12:13], v[28:29]
    v_pk_add_f32 v[14:15], v[14:15], v[30:31]
    v_pk_add_f32 v[16:17], v[16:17], v[32:33]
    v_pk_add_f32 v[18:19], v[18:19], v[34:35]
    v_pk_add_f32 v[20:21], v[20:21], v[36:37]
    v_pk_add_f32 v[22:23], v[22:23], v[38:39]
    s_waitcnt lgkmcnt(0)
    v_pk_add_f32 v[8:9], v[8:9], v[40:41]
    v_pk_add_f32 v[10:11], v[10:11], v[42:43]
    v_pk_add_f32 v[12:13], v[12:13], v[44:45]
    v_pk_add_f32 v[14:15], v[14:15], v[46:47]
    v_pk_add_f32 v[16:17], v[16:17], v[48:49]
    v_pk_add_f32 v[18:19], v[18:19], v[50:51]
    v_pk_add_f32 v[20:21], v[20:21], v[52:53]
    v_pk_add_f32 v[22:23], v[22:23], v[54:55]
    v_pk_mul_f32 v[8:9], v[8:9], v[112:113]
    v_pk_mul_f32 v[10:11], v[10:11], v[114:115]
    v_pk_mul_f32 v[12:13], v[12:13], v[116:117]
    v_pk_mul_f32 v[14:15], v[14:15], v[118:119]
    v_pk_mul_f32 v[16:17], v[16:17], v[120:121]
    v_pk_mul_f32 v[18:19], v[18:19], v[122:123]
    v_pk_mul_f32 v[20:21], v[20:21], v[124:125]
    v_pk_mul_f32 v[22:23], v[22:23], v[126:127]
    v_cvt_pk_bf16_f32 v64, v8, v9
    v_cvt_pk_bf16_f32 v65, v10, v11
    v_cvt_pk_bf16_f32 v66, v12, v13
    v_cvt_pk_bf16_f32 v67, v14, v15
    v_cvt_pk_bf16_f32 v68, v16, v17
    v_cvt_pk_bf16_f32 v69, v18, v19
    v_cvt_pk_bf16_f32 v70, v20, v21
    v_cvt_pk_bf16_f32 v71, v22, v23
    v_cndmask_b32 v64, v64, v89, vcc
    v_cndmask_b32 v65, v65, v89, vcc
    v_cndmask_b32 v66, v66, v89, vcc
    v_cndmask_b32 v67, v67, v89, vcc
    v_cndmask_b32 v68, v68, v89, vcc
    v_cndmask_b32 v69, v69, v89, vcc
    v_cndmask_b32 v70, v70, v89, vcc
    v_cndmask_b32 v71, v71, v89, vcc
    s_mov_b32 exec_lo, 0x3fffff
    s_mov_b32 exec_hi, 0x3fffff
    buffer_store_dwordx4 v[64:67], v87, s[32:35], s72 offen offset:1280 sc1
    buffer_store_dwordx4 v[68:71], v87, s[32:35], s72 offen offset:1984 sc1
    s_mov_b64 exec, -1
    v_mov_b32 v122, 0
L_jobdone:
L_a2:
    s_waitcnt lgkmcnt(0)
    s_barrier
    ds_read_b64_tr_b16 a[64:65], v95 offset:24576
    ds_read_b64_tr_b16 a[66:67], v95 offset:25344
    ds_read_b128 v[28:31], v60
    ds_read_b128 v[24:27], v56
    ds_read_b64_tr_b16 a[68:69], v95 offset:30720
    ds_read_b64_tr_b16 a[70:71], v95 offset:31488
    ds_read_b128 v[36:39], v61
    ds_read_b128 v[32:35], v57
    v_lshrrev_b32 v88, 4, v0
    v_xor_b32 v88, v88, v0
    v_and_b32 v88, 1, v88
    v_cmp_eq_u32 vcc, 0, v88
    v_mov_b32 v88, s42
    s_nop 0
    v_cndmask_b32 v116, 0, v88, vcc
    v_cndmask_b32 v117, 0, v88, vcc
    v_cndmask_b32 v118, 0, v88, vcc
    v_cndmask_b32 v119, 0, v88, vcc
    s_setprio 1
    s_waitcnt lgkmcnt(4)
    v_mfma_f32_32x32x16_bf16 v[96:111], a[64:67], v[28:31], 0
    ds_read_b64_tr_b16 a[72:73], v95 offset:36864
    ds_read_b64_tr_b16 a[74:75], v95 offset:37632
    ds_read_b128 v[44:47], v62
    ds_read_b128 v[40:43], v58
    v_mfma_f32_32x32x16_bf16 v[8:23], a[64:67], v[24:27], 0
    ds_read_b64_tr_b16 a[76:77], v95 offset:43008
    ds_read_b64_tr_b16 a[78:79], v95 offset:43776
    ds_read_b128 v[52:55], v63
    ds_read_b128 v[48:51], v59
    v_and_b32 v88, 15, v0
    s_lshl_b32 s70, s38, 4
    v_add_u32 v88, s70, v88
    v_lshlrev_b32 v88, 7, v88
    v_mfma_f32_16x16x32_bf16 v[112:115], a[64:67], v[116:119], 0
    s_cmp_lg_u32 s44, 0
    s_cbranch_scc1 L_tm_5
    s_add_u32 s70, s69, 2
    s_cmp_ge_u32 s70, 5
    s_cselect_b32 s71, 5, 0
    s_sub_u32 s70, s70, s71
    s_mul_i32 s70, s70, 163840
    s_add_u32 s70, s70, s75
    s_add_u32 s71, s70, 20480
    s_add_u32 m0, s73, 131072
    s_nop 0
    buffer_load_dwordx4 v72, s[12:15], s70 offen lds
    s_add_u32 m0, s73, 132096
    s_nop 0
    buffer_load_dwordx4 v73, s[12:15], s70 offen lds
    s_add_u32 m0, s73, 133120
    s_nop 0
    buffer_load_dwordx4 v74, s[12:15], s70 offen lds
    s_add_u32 m0, s73, 134144
    s_nop 0
    buffer_load_dwordx4 v72, s[12:15], s71 offen lds
    s_add_u32 m0, s73, 135168
    s_nop 0
    buffer_load_dwordx4 v73, s[12:15], s71 offen lds
    s_add_u32 m0, s73, 136192
    s_nop 0
    buffer_load_dwordx4 v74, s[12:15], s71 offen lds
L_tm_5:
    s_setprio 0
    s_waitcnt lgkmcnt(8)
    v_mfma_f32_32x32x16_bf16 v[96:111], a[68:71], v[36:39], v[96:111]
    s_cmp_eq_u32 s69, 4
    s_cselect_b32 s72, -4, 1
    s_lshl_b32 s72, s72, 10
    v_add_u32 v56, s72, v56
    v_add_u32 v57, s72, v57
    v_add_u32 v58, s72, v58
    v_add_u32 v59, s72, v59
    v_add_u32 v60, s72, v60
    v_add_u32 v61, s72, v61
    v_add_u32 v62, s72, v62
    v_add_u32 v63, s72, v63
    v_mfma_f32_32x32x16_bf16 v[8:23], a[68:71], v[32:35], v[8:23]
    s_mul_i32 s70, s38, 3072
    s_add_u32 s70, s70, 135168
    v_add_u32 v80, s70, v1
    s_xor_b32 s70, s38, 4
    s_mul_i32 s70, s70, 3072
    s_add_u32 s70, s70, 135168
    v_add_u32 v81, s70, v1
    v_mfma_f32_16x16x32_bf16 v[112:115], a[68:71], v[116:119], v[112:115]
    s_cmp_lg_u32 s39, 3
    s_cbranch_scc1 L_nofl1_6
    s_waitcnt vmcnt(8)
    s_mov_b32 s79, 0x200000
L_tok_7:
    v_readfirstlane_b32 s40, v90
    v_readfirstlane_b32 s41, v91
    s_nop 0
    s_cmp_lg_u32 s41, 0
    s_cselect_b32 s70, s40, 0
    s_cmp_lg_u32 s70, 0
    s_cbranch_scc1 L_tok_7_ok
    buffer_load_dwordx2 v[90:91], off, s[28:31], 0 sc1
    s_sub_u32 s79, s79, 1
    s_waitcnt vmcnt(0)
    s_cbranch_scc0 L_tok_7
L_tok_7_ok:
    s_lshl_b32 s71, s36, 2
    s_add_u32 s71, s71, s37
    s_lshl_b32 s70, s71, 7
    s_add_u32 s70, s70, 0
    v_mov_b32 v120, s40
    v_mov_b32 v121, s41
    v_mov_b32 v123, 0
    s_mov_b64 exec, 1
    s_waitcnt vmcnt(6)
    buffer_store_dwordx4 v[120:123], off, s[32:35], s70 sc1
    s_mov_b64 exec, -1
L_nofl1_6:
    s_waitcnt lgkmcnt(2)
    s_cmp_lg_u32 s44, 1
    s_cbranch_scc1 L_tm_8
    s_waitcnt vmcnt(0)
L_tm_8:
    s_barrier
    s_setprio 3
    v_mfma_f32_32x32x16_bf16 v[96:111], a[72:75], v[44:47], v[96:111]
    ds_read_b64_tr_b16 a[80:81], v95 offset:0
    ds_read_b64_tr_b16 a[82:83], v95 offset:768
    ds_read_b128 a[4:7], v60
    ds_read_b128 a[0:3], v56
    v_mfma_f32_32x32x16_bf16 v[8:23], a[72:75], v[40:43], v[8:23]
    ds_read_b64_tr_b16 a[84:85], v95 offset:6144
    ds_read_b64_tr_b16 a[86:87], v95 offset:6912
    ds_read_b128 a[12:15], v61
    ds_read_b128 a[8:11], v57
    v_and_b32 v82, 1, v0
    v_lshlrev_b32 v82, 6, v82
    v_and_b32 v83, 48, v0
    s_lshl_b32 s70, s38, 7
    s_add_u32 s70, s70, 160768
    v_add3_u32 v82, v82, v83, s70
    v_mfma_f32_16x16x32_bf16 v[112:115], a[72:75], v[116:119], v[112:115]
    s_cmp_lg_u32 s44, 1
    s_cbranch_scc1 L_tm_9
    s_add_u32 s70, s69, 3
    s_cmp_ge_u32 s70, 5
    s_cselect_b32 s71, 5, 0
    s_sub_u32 s70, s70, s71
    s_mul_i32 s70, s70, 163840
    s_add_u32 s70, s70, s75
    s_add_u32 s71, s70, 20480
    s_add_u32 m0, s73, 106496
    s_nop 0
    buffer_load_dwordx4 v72, s[12:15], s70 offen lds
    s_add_u32 m0, s73, 107520
    s_nop 0
    buffer_load_dwordx4 v73, s[12:15], s70 offen lds
    s_add_u32 m0, s73, 108544
    s_nop 0
    buffer_load_dwordx4 v74, s[12:15], s70 offen lds
    s_add_u32 m0, s73, 109568
    s_nop 0
    buffer_load_dwordx4 v72, s[12:15], s71 offen lds
    s_add_u32 m0, s73, 110592
    s_nop 0
    buffer_load_dwordx4 v73, s[12:15], s71 offen lds
    s_add_u32 m0, s73, 111616
    s_nop 0
    buffer_load_dwordx4 v74, s[12:15], s71 offen lds
L_tm_9:
    s_setprio 2
    s_waitcnt lgkmcnt(8)
    v_mfma_f32_32x32x16_bf16 v[96:111], a[76:79], v[52:55], v[96:111]
    ds_read_b64_tr_b16 a[88:89], v95 offset:12288
    ds_read_b64_tr_b16 a[90:91], v95 offset:13056
    ds_read_b128 a[20:23], v62
    ds_read_b128 a[16:19], v58
    v_mfma_f32_32x32x16_bf16 v[8:23], a[76:79], v[48:51], v[8:23]
    ds_read_b64_tr_b16 a[92:93], v95 offset:18432
    ds_read_b64_tr_b16 a[94:95], v95 offset:19200
    ds_read_b128 a[28:31], v63
    ds_read_b128 a[24:27], v59
    s_cmp_eq_u32 s69, 3
    s_cselect_b32 s72, -4, 1
    s_lshl_b32 s72, s72, 10
    v_add_u32 v56, s72, v56
    v_add_u32 v57, s72, v57
    v_add_u32 v58, s72, v58
    v_add_u32 v59, s72, v59
    v_add_u32 v60, s72, v60
    v_add_u32 v61, s72, v61
    v_add_u32 v62, s72, v62
    v_add_u32 v63, s72, v63
    v_mfma_f32_16x16x32_bf16 v[112:115], a[76:79], v[116:119], v[112:115]
    s_setprio 1
    s_waitcnt lgkmcnt(12)
    v_mfma_f32_32x32x16_bf16 v[96:111], a[80:83], a[4:7], v[96:111]
    ds_read_b128 v[28:31], v60
    ds_read_b128 v[24:27], v56
    v_mfma_f32_32x32x16_bf16 v[8:23], a[80:83], a[0:3], v[8:23]
    ds_read_b128 v[36:39], v61
    ds_read_b128 v[32:35], v57
    v_lshrrev_b32 v87, 5, v0
    v_lshlrev_b32 v83, 4, v87
    s_lshl_b32 s70, s45, 7
    s_add_u32 s70, s70, 160768
    v_add_u32 v83, s70, v83
    v_mfma_f32_16x16x32_bf16 v[112:115], a[80:83], v[116:119], v[112:115]
    s_setprio 0
    s_waitcnt lgkmcnt(12)
    v_mfma_f32_32x32x16_bf16 v[96:111], a[84:87], a[12:15], v[96:111]
    ds_read_b128 v[44:47], v62
    ds_read_b128 v[40:43], v58
    v_mfma_f32_32x32x16_bf16 v[8:23], a[84:87], a[8:11], v[8:23]
    ds_read_b128 v[52:55], v63
    ds_read_b128 v[48:51], v59
    v_and_b32 v86, 31, v0
    v_lshlrev_b32 v85, 2, v86
    s_lshl_b32 s70, s44, 7
    s_add_u32 s70, s70, 160000
    v_add_u32 v85, s70, v85
    v_mfma_f32_16x16x32_bf16 v[112:115], a[84:87], v[116:119], v[112:115]
    s_waitcnt lgkmcnt(10)
    s_cmp_lg_u32 s44, 0
    s_cbranch_scc1 L_tm_10
    s_waitcnt vmcnt(0)
L_tm_10:
    s_barrier
    s_setprio 3
    v_mfma_f32_32x32x16_bf16 v[96:111], a[88:91], a[20:23], v[96:111]
    ds_read_b64_tr_b16 a[64:65], v75 offset:0
    ds_read_b64_tr_b16 a[66:67], v75 offset:768
    s_cmp_eq_u32 s69, 2
    s_cselect_b32 s72, -4, 1
    s_lshl_b32 s72, s72, 10
    v_add_u32 v56, s72, v56
    v_add_u32 v57, s72, v57
    v_add_u32 v58, s72, v58
    v_add_u32 v59, s72, v59
    v_mfma_f32_32x32x16_bf16 v[8:23], a[88:91], a[16:19], v[8:23]
    ds_read_b64_tr_b16 a[68:69], v75 offset:6144
    ds_read_b64_tr_b16 a[70:71], v75 offset:6912
    ds_read_b32 v84, v85
    ds_read_b32 v85, v85 offset:256
    v_lshlrev_b32 v71, 3, v86
    v_add_u32 v71, 103424, v71
    v_mfma_f32_16x16x32_bf16 v[112:115], a[88:91], v[116:119], v[112:115]
    s_cmp_lg_u32 s44, 0
    s_cbranch_scc1 L_tm_11
    s_add_u32 s70, s69, 4
    s_cmp_ge_u32 s70, 5
    s_cselect_b32 s71, 5, 0
    s_sub_u32 s70, s70, s71
    s_mul_i32 s70, s70, 163840
    s_add_u32 s70, s70, s75
    s_add_u32 s71, s70, 20480
    s_add_u32 m0, s73, 81920
    s_nop 0
    buffer_load_dwordx4 v72, s[12:15], s70 offen lds
    s_add_u32 m0, s73, 82944
    s_nop 0
    buffer_load_dwordx4 v73, s[12:15], s70 offen lds
    s_add_u32 m0, s73, 83968
    s_nop 0
    buffer_load_dwordx4 v74, s[12:15], s70 offen lds
    s_add_u32 m0, s73, 84992
    s_nop 0
    buffer_load_dwordx4 v72, s[12:15], s71 offen lds
    s_add_u32 m0, s73, 86016
    s_nop 0
    buffer_load_dwordx4 v73, s[12:15], s71 offen lds
    s_add_u32 m0, s73, 87040
    s_nop 0
    buffer_load_dwordx4 v74, s[12:15], s71 offen lds
L_tm_11:
    s_setprio 2
    s_waitcnt lgkmcnt(14)
    v_mfma_f32_32x32x16_bf16 v[96:111], a[92:95], a[28:31], v[96:111]
    ds_read_b64_tr_b16 a[72:73], v75 offset:12288
    ds_read_b64_tr_b16 a[74:75], v75 offset:13056
    v_add_u32 v60, s72, v60
    v_add_u32 v61, s72, v61
    v_add_u32 v62, s72, v62
    v_add_u32 v63, s72, v63
    v_mfma_f32_32x32x16_bf16 v[8:23], a[92:95], a[24:27], v[8:23]
    ds_read_b64_tr_b16 a[76:77], v75 offset:18432
    ds_read_b64_tr_b16 a[78:79], v75 offset:19200
    v_mov_b32 v70, 104000
    v_cndmask_b32 v71, v70, v71, s[90:91]
    v_min_u32 v86, 21, v86
    v_mul_u32_u24 v87, 22, v87
    v_mfma_f32_16x16x32_bf16 v[112:115], a[92:95], v[116:119], v[112:115]
    s_setprio 1
    s_waitcnt lgkmcnt(8)
    v_mfma_f32_32x32x16_bf16 v[96:111], a[64:67], v[28:31], v[96:111]
    ds_read_b128 a[4:7], v60
    ds_read_b128 a[0:3], v56
    v_mfma_f32_32x32x16_bf16 v[8:23], a[64:67], v[24:27], v[8:23]
    ds_read_b128 a[12:15], v61
    ds_read_b128 a[8:11], v57
    v_add_u32 v86, v86, v87
    v_lshlrev_b32 v86, 4, v86
    v_add_u32 v70, 102400, v86
    s_lshl_b32 s70, s38, 2
    s_add_u32 s70, s70, 159744
    v_mov_b32 v87, s70
    v_mfma_f32_16x16x32_bf16 v[112:115], a[64:67], v[116:119], v[112:115]
    s_setprio 0
    s_waitcnt lgkmcnt(10)
    v_mfma_f32_32x32x16_bf16 v[96:111], a[68:71], v[36:39], v[96:111]
    ds_read_b128 a[20:23], v62
    ds_read_b128 a[16:19], v58
    v_mfma_f32_32x32x16_bf16 v[8:23], a[68:71], v[32:35], v[8:23]
    ds_read_b128 a[28:31], v63
    ds_read_b128 a[24:27], v59
    v_and_b32 v89, 7, v0
    v_lshlrev_b32 v89, 2, v89
    v_add_u32 v89, 159744, v89
    s_add_u32 s76, s77, 262144
    v_mfma_f32_16x16x32_bf16 v[112:115], a[68:71], v[116:119], v[112:115]
    s_waitcnt lgkmcnt(8)
    s_cmp_lg_u32 s44, 1
    s_cbranch_scc1 L_tm_12
    s_waitcnt vmcnt(0)
L_tm_12:
    s_barrier
    s_mov_b32 s79, 0x200000
L_tok_13:
    v_readfirstlane_b32 s40, v90
    v_readfirstlane_b32 s41, v91
    s_nop 0
    s_cmp_lg_u32 s41, 0
    s_cselect_b32 s70, s40, 0
    s_cmp_lg_u32 s70, 0
    s_cbranch_scc1 L_tok_13_ok
    buffer_load_dwordx2 v[90:91], off, s[28:31], 0 sc1
    s_sub_u32 s79, s79, 1
    s_waitcnt vmcnt(0)
    s_cbranch_scc0 L_tok_13
L_tok_13_ok:
    s_setprio 3
    v_mfma_f32_32x32x16_bf16 v[96:111], a[72:75], v[44:47], v[96:111]
    ds_read_b64_tr_b16 a[80:81], v95 offset:24576
    ds_read_b64_tr_b16 a[82:83], v95 offset:25344
    s_cmp_eq_u32 s69, 1
    s_cselect_b32 s72, -4, 1
    s_lshl_b32 s72, s72, 10
    v_add_u32 v56, s72, v56
    v_add_u32 v57, s72, v57
    v_add_u32 v58, s72, v58
    v_add_u32 v59, s72, v59
    v_mfma_f32_32x32x16_bf16 v[8:23], a[72:75], v[40:43], v[8:23]
    ds_read_b64_tr_b16 a[84:85], v95 offset:30720
    ds_read_b64_tr_b16 a[86:87], v95 offset:31488
    v_mfma_f32_16x16x32_bf16 v[112:115], a[72:75], v[116:119], v[112:115]
    s_setprio 2
    v_mfma_f32_32x32x16_bf16 v[96:111], a[76:79], v[52:55], v[96:111]
    ds_read_b64_tr_b16 a[88:89], v95 offset:36864
    ds_read_b64_tr_b16 a[90:91], v95 offset:37632
    v_add_u32 v60, s72, v60
    v_add_u32 v61, s72, v61
    v_add_u32 v62, s72, v62
    v_add_u32 v63, s72, v63
    v_mfma_f32_32x32x16_bf16 v[8:23], a[76:79], v[48:51], v[8:23]
    ds_read_b64_tr_b16 a[92:93], v95 offset:43008
    ds_read_b64_tr_b16 a[94:95], v95 offset:43776
    v_mfma_f32_16x16x32_bf16 v[112:115], a[76:79], v[116:119], v[112:115]
    s_setprio 1
    s_waitcnt lgkmcnt(6)
    v_mfma_f32_32x32x16_bf16 v[96:111], a[80:83], a[4:7], v[96:111]
    ds_read_b128 v[28:31], v60
    ds_read_b128 v[24:27], v56
    v_mfma_f32_32x32x16_bf16 v[8:23], a[80:83], a[0:3], v[8:23]
    ds_read_b128 v[36:39], v61
    ds_read_b128 v[32:35], v57
    v_mfma_f32_16x16x32_bf16 v[112:115], a[80:83], v[116:119], v[112:115]
    s_setprio 0
    s_waitcnt lgkmcnt(8)
    v_mfma_f32_32x32x16_bf16 v[96:111], a[84:87], a[12:15], v[96:111]
    ds_read_b128 v[44:47], v62
    ds_read_b128 v[40:43], v58
    v_mfma_f32_32x32x16_bf16 v[8:23], a[84:87], a[8:11], v[8:23]
    ds_read_b128 v[52:55], v63
    ds_read_b128 v[48:51], v59
    v_mfma_f32_16x16x32_bf16 v[112:115], a[84:87], v[116:119], v[112:115]
    s_waitcnt lgkmcnt(8)
    s_cmp_lg_u32 s44, 0
    s_cbranch_scc1 L_tm_14
    s_waitcnt vmcnt(0)
L_tm_14:
    s_barrier
    s_setprio 3
    v_mfma_f32_32x32x16_bf16 v[96:111], a[88:91], a[20:23], v[96:111]
    ds_read_b64_tr_b16 a[64:65], v95 offset:0
    ds_read_b64_tr_b16 a[66:67], v95 offset:768
    v_mfma_f32_32x32x16_bf16 v[8:23], a[88:91], a[16:19], v[8:23]
    ds_read_b64_tr_b16 a[68:69], v95 offset:6144
    ds_read_b64_tr_b16 a[70:71], v95 offset:6912
    v_mfma_f32_16x16x32_bf16 v[112:115], a[88:91], v[116:119], v[112:115]
    v_lshrrev_b32 v92, 3, v0
    s_lshl_b32 s70, s38, 3
    v_add_u32 v92, s70, v92
    v_and_b32 v93, 7, v0
    v_lshlrev_b32 v93, 4, v93
    v_mad_u32_u24 v90, v92, s86, v93
    v_mul_u32_u24 v91, 144, v92
    v_add_u32 v91, v91, v93
    s_setprio 2
    v_mfma_f32_32x32x16_bf16 v[96:111], a[92:95], a[28:31], v[96:111]
    ds_read_b64_tr_b16 a[72:73], v95 offset:12288
    ds_read_b64_tr_b16 a[74:75], v95 offset:13056
    v_mfma_f32_32x32x16_bf16 v[8:23], a[92:95], a[24:27], v[8:23]
    ds_read_b64_tr_b16 a[76:77], v95 offset:18432
    ds_read_b64_tr_b16 a[78:79], v95 offset:19200
    v_mfma_f32_16x16x32_bf16 v[112:115], a[92:95], v[116:119], v[112:115]
    buffer_load_dwordx4 v[124:127], v88, s[32:35], 0 offen sc1
    s_setprio 2
    s_waitcnt lgkmcnt(6)
    v_mfma_f32_16x16x32_bf16 v[112:115], a[64:67], v[116:119], v[112:115]
    v_mfma_f32_32x32x16_bf16 v[96:111], a[64:67], v[28:31], v[96:111]
    v_mul_f32 v85, 0x3ea52b5c, v85
    v_lshrrev_b32 v2, 4, v0
    v_lshlrev_b32 v3, 3, v2
    v_bfe_u32 v4, v0, 2, 2
    v_and_b32 v94, 3, v0
    v_lshlrev_b32 v94, 3, v94
    v_mul_u32_u24 v4, 144, v4
    s_waitcnt lgkmcnt(4)
    v_mfma_f32_16x16x32_bf16 v[112:115], a[68:71], v[116:119], v[112:115]
    v_mfma_f32_32x32x16_bf16 v[96:111], a[68:71], v[36:39], v[96:111]
    s_lshl_b32 s70, s45, 5
    v_add3_u32 v94, v94, v4, s70
    v_mov_b32 v4, 144
    v_bfe_u32 v92, s80, v3, 8
    v_mad_u32_u24 v92, v92, v4, v94
    v_bfe_u32 v93, s81, v3, 8
    s_waitcnt lgkmcnt(2)
    v_mfma_f32_16x16x32_bf16 v[112:115], a[72:75], v[116:119], v[112:115]
    v_mfma_f32_32x32x16_bf16 v[96:111], a[72:75], v[44:47], v[96:111]
    v_mad_u32_u24 v93, v93, v4, v94
    v_bfe_u32 v120, s82, v3, 8
    v_mad_u32_u24 v120, v120, v4, v94
    v_bfe_u32 v121, s83, v3, 8
    v_mad_u32_u24 v121, v121, v4, v94
    v_bfe_u32 v122, s84, v3, 8
    s_waitcnt lgkmcnt(0)
    v_mfma_f32_16x16x32_bf16 v[112:115], a[76:79], v[116:119], v[112:115]
    v_mfma_f32_32x32x16_bf16 v[96:111], a[76:79], v[52:55], v[96:111]
    v_mad_u32_u24 v122, v122, v4, v94
    v_bfe_u32 v123, s85, v3, 8
    v_mad_u32_u24 v123, v123, v4, v94
    v_and_b32 v94, 15, v0
    v_mul_u32_u24 v94, 1280, v94
    v_add_u32 v94, v94, v3
    s_setprio 1
    v_mfma_f32_32x32x16_bf16 v[8:23], a[64:67], v[24:27], v[8:23]
    ds_write_b128 v82, v[112:115]
    v_mfma_f32_32x32x16_bf16 v[8:23], a[68:71], v[32:35], v[8:23]
    s_nop 1
    ds_write_b128 v80, v[96:99] offset:0
    v_mfma_f32_32x32x16_bf16 v[8:23], a[72:75], v[40:43], v[8:23]
    ds_write_b128 v80, v[100:103] offset:1024
    v_mfma_f32_32x32x16_bf16 v[8:23], a[76:79], v[48:51], v[8:23]
    ds_write_b128 v80, v[104:107] offset:2048
    v_add_u32 v30, 102400, v1
    v_mov_b32 v31, v89
    v_mov_b32 v50, 0x44c03bd7
    s_waitcnt vmcnt(0)
    v_cmp_ne_u64 vcc, s[40:41], v[124:125]
    s_cbranch_vccz L_ok_15
    s_mov_b32 s79, 0x200000
L_poll_16:
    buffer_load_dwordx4 v[124:127], v88, s[32:35], 0 offen sc1
    s_sub_u32 s79, s79, 1
    s_cbranch_scc1 L_poll_16_d
    s_waitcnt vmcnt(0)
    v_cmp_ne_u64 vcc, s[40:41], v[124:125]
    s_cbranch_vccnz L_poll_16
L_poll_16_d:
L_ok_15:
    v_max_f32_dpp v126, v126, v126 row_ror:8 row_mask:0xf bank_mask:0xf
    s_nop 1
    v_max_f32_dpp v126, v126, v126 row_ror:4 row_mask:0xf bank_mask:0xf
    s_nop 1
    v_max_f32_dpp v126, v126, v126 row_ror:2 row_mask:0xf bank_mask:0xf
    s_nop 1
    v_max_f32_dpp v126, v126, v126 row_ror:1 row_mask:0xf bank_mask:0xf
    ds_write_b32 v87, v126 offset:32
    s_waitcnt lgkmcnt(0)
    s_barrier
    ds_read_b128 v[96:99], v81 offset:0
    ds_read_b128 v[100:103], v81 offset:1024
    ds_read_b128 v[104:107], v81 offset:2048
    s_add_u32 m0, s77, 102400
    s_add_u32 s70, s76, 0
    buffer_load_dwordx4 v1, s[32:35], s70 offen sc1 lds
    ds_read_b128 v[108:111], v83 offset:0
    ds_read_b128 v[52:55], v83 offset:512
    ds_read_b128 v[112:115], v83 offset:32
    ds_read_b128 v[56:59], v83 offset:544
    ds_read_b128 v[116:119], v83 offset:64
    ds_read_b128 v[60:63], v83 offset:576
    ds_read_b32 v86, v89 offset:32
    s_add_u32 m0, s77, 110592
    s_add_u32 s70, s76, 8192
    buffer_load_dwordx4 v1, s[32:35], s70 offen sc1 lds
    s_waitcnt lgkmcnt(7)
    v_add_f32 v8, v8, v96
    v_add_f32 v9, v9, v97
    v_add_f32 v10, v10, v98
    v_add_f32 v11, v11, v99
    v_add_f32 v12, v12, v100
    v_add_f32 v13, v13, v101
    v_add_f32 v14, v14, v102
    v_add_f32 v15, v15, v103
    v_add_f32 v16, v16, v104
    v_add_f32 v17, v17, v105
    v_add_f32 v18, v18, v106
    v_add_f32 v19, v19, v107
    s_add_u32 m0, s77, 118784
    s_add_u32 s70, s76, 16384
    buffer_load_dwordx4 v1, s[32:35], s70 offen sc1 lds
    s_waitcnt lgkmcnt(0)
    v_fmac_f32 v8, v108, v84
    v_fmac_f32 v9, v109, v84
    v_fmac_f32 v10, v110, v84
    v_fmac_f32 v11, v111, v84
    v_fmac_f32 v12, v112, v84
    v_fmac_f32 v13, v113, v84
    v_fmac_f32 v14, v114, v84
    v_fmac_f32 v15, v115, v84
    v_fmac_f32 v16, v116, v84
    v_fmac_f32 v17, v117, v84
    v_fmac_f32 v18, v118, v84
    v_fmac_f32 v19, v119, v84
    v_fmac_f32 v8, v52, v84
    v_fmac_f32 v9, v53, v84
    v_fmac_f32 v10, v54, v84
    v_fmac_f32 v11, v55, v84
    v_fmac_f32 v12, v56, v84
    v_fmac_f32 v13, v57, v84
    v_fmac_f32 v14, v58, v84
    v_fmac_f32 v15, v59, v84
    v_fmac_f32 v16, v60, v84
    v_fmac_f32 v17, v61, v84
    v_fmac_f32 v18, v62, v84
    v_fmac_f32 v19, v63, v84
    s_add_u32 m0, s77, 126976
    s_add_u32 s70, s76, 24576
    buffer_load_dwordx4 v1, s[32:35], s70 offen sc1 lds
    v_mul_f32 v8, v85, v8
    v_mul_f32 v9, v85, v9
    v_mul_f32 v10, v85, v10
    v_mul_f32 v11, v85, v11
    v_mul_f32 v12, v85, v12
    v_mul_f32 v13, v85, v13
    v_mul_f32 v14, v85, v14
    v_mul_f32 v15, v85, v15
    v_mul_f32 v16, v85, v16
    v_mul_f32 v17, v85, v17
    v_mul_f32 v18, v85, v18
    v_mul_f32 v19, v85, v19
    v_max_f32_dpp v86, v86, v86 row_ror:8 row_mask:0xf bank_mask:0xf
    s_nop 1
    v_max_f32_dpp v86, v86, v86 row_ror:4 row_mask:0xf bank_mask:0xf
    s_nop 1
    v_max_f32_dpp v86, v86, v86 row_ror:2 row_mask:0xf bank_mask:0xf
    s_nop 1
    v_max_f32_dpp v86, v86, v86 row_ror:1 row_mask:0xf bank_mask:0xf
    v_cvt_pk_bf16_f32 v24, v8, v9
    v_cvt_pk_bf16_f32 v25, v10, v11
    v_cvt_pk_bf16_f32 v26, v12, v13
    v_cvt_pk_bf16_f32 v27, v14, v15
    v_cvt_pk_bf16_f32 v28, v16, v17
    v_cvt_pk_bf16_f32 v29, v18, v19
    v_mul_f32 v52, v8, v8
    v_mul_f32 v53, v9, v9
    v_mul_f32 v54, v16, v16
    v_mul_f32 v55, v17, v17
    v_fma_f32 v52, v10, v10, v52
    v_fma_f32 v53, v11, v11, v53
    v_fma_f32 v54, v18, v18, v54
    v_fma_f32 v55, v19, v19, v55
    v_fma_f32 v52, v12, v12, v52
    v_fma_f32 v53, v13, v13, v53
    v_fma_f32 v52, v14, v14, v52
    v_fma_f32 v53, v15, v15, v53
    v_add_f32 v54, v54, v55
    v_add_f32 v48, v52, v53
    v_cndmask_b32 v54, 0, v54, s[90:91]
    v_add_f32 v48, v48, v54
    v_mov_b32 v52, v48
    s_nop 1
    v_permlane32_swap_b32 v48, v52
    v_add_f32 v48, v48, v52
    v_mul_f32 v48, v48, v86
    v_cndmask_b32 v29, 0, v29, s[90:91]
    v_sqrt_f32 v49, v48
    v_cmp_nle_f32 vcc, v48, v50
    s_waitcnt vmcnt(2)
    s_barrier
    ds_read_b128 v[64:67], v30
    ds_read_b64 v[68:69], v71
    ds_read_b128 v[72:75], v70 offset:1280
    v_mul_f32 v49, 0xbf828f5c, v49
    s_cmp_lg_u64 vcc, 0
    v_cvt_pk_bf16_f32 v49, v49, 0
    s_cselect_b32 s70, 1, 0
    v_cndmask_b32 v28, v49, v28, s[90:91]
    v_mov_b32 v50, s70
    s_waitcnt lgkmcnt(1)
    v_mfma_f32_32x32x16_bf16 v[32:47], v[64:67], v[24:27], 0
    ds_read_b128 v[64:67], v30 offset:2688
    ds_write_b32 v87, v50
    v_mfma_f32_32x32x8_bf16 v[32:47], v[68:69], v[28:29], v[32:47]
    ds_read_b64 v[68:69], v71 offset:2688
    s_setprio 3
    s_nop 9
    v_exp_f32 v32, v32
    v_exp_f32 v33, v33
    ds_read_b128 v[76:79], v70 offset:1984
    v_exp_f32 v34, v34
    v_exp_f32 v35, v35
    v_cvt_pk_bf16_f32 v32, v32, v33
    v_cvt_pk_bf16_f32 v33, v34, v35
    v_exp_f32 v36, v36
    s_mul_i32 s70, s86, 0
    s_add_u32 s70, s70, s87
    buffer_load_dwordx4 a[32:35], v90, s[20:23], s70 offen
    v_exp_f32 v37, v37
    s_waitcnt lgkmcnt(3)
    v_mfma_f32_32x32x16_bf16 v[48:63], v[64:67], v[24:27], 0
    ds_read_b128 v[64:67], v30 offset:5376
    v_exp_f32 v38, v38
    v_exp_f32 v39, v39
    s_setprio 2
    v_cvt_pk_bf16_f32 v34, v36, v37
    v_cvt_pk_bf16_f32 v35, v38, v39
    v_exp_f32 v40, v40
    v_exp_f32 v41, v41
    s_waitcnt lgkmcnt(2)
    v_mfma_f32_32x32x8_bf16 v[48:63], v[68:69], v[28:29], v[48:63]
    ds_read_b64 v[68:69], v71 offset:5376
    v_exp_f32 v42, v42
    v_exp_f32 v43, v43
    v_cvt_pk_bf16_f32 v40, v40, v41
    v_cvt_pk_bf16_f32 v41, v42, v43
    v_exp_f32 v44, v44
    s_mul_i32 s70, s86, 64
    s_add_u32 s70, s70, s87
    buffer_load_dwordx4 a[36:39], v90, s[20:23], s70 offen
    v_exp_f32 v45, v45
    v_mfma_f32_32x32x16_bf16 v[8:23], v[72:75], v[32:35], 0
    ds_read_b128 v[72:75], v70 offset:3968
    v_exp_f32 v46, v46
    v_exp_f32 v47, v47
    v_cvt_pk_bf16_f32 v42, v44, v45
    v_cvt_pk_bf16_f32 v43, v46, v47
    s_setprio 1
    v_exp_f32 v48, v48
    v_exp_f32 v49, v49
    s_waitcnt lgkmcnt(3)
    v_mfma_f32_32x32x16_bf16 v[8:23], v[76:79], v[40:43], v[8:23]
    ds_read_b128 v[76:79], v70 offset:4672
    v_exp_f32 v50, v50
    v_exp_f32 v51, v51
    v_cvt_pk_bf16_f32 v48, v48, v49
    v_cvt_pk_bf16_f32 v49, v50, v51
    v_exp_f32 v52, v52
    s_mul_i32 s70, s86, 128
    s_add_u32 s70, s70, s87
    buffer_load_dwordx4 a[40:43], v90, s[20:23], s70 offen
    v_exp_f32 v53, v53
    s_waitcnt lgkmcnt(3)
    v_mfma_f32_32x32x16_bf16 v[32:47], v[64:67], v[24:27], 0
    ds_read_b128 v[64:67], v30 offset:8064
    v_exp_f32 v54, v54
    v_exp_f32 v55, v55
    s_setprio 0
    v_cvt_pk_bf16_f32 v50, v52, v53
    v_cvt_pk_bf16_f32 v51, v54, v55
    v_exp_f32 v56, v56
    v_exp_f32 v57, v57
    s_waitcnt lgkmcnt(3)
    v_mfma_f32_32x32x8_bf16 v[32:47], v[68:69], v[28:29], v[32:47]
    ds_read_b64 v[68:69], v71 offset:8064
    v_exp_f32 v58, v58
    v_exp_f32 v59, v59
    v_cvt_pk_bf16_f32 v56, v56, v57
    v_cvt_pk_bf16_f32 v57, v58, v59
    v_exp_f32 v60, v60
    v_exp_f32 v61, v61
    s_waitcnt lgkmcnt(3)
    v_mfma_f32_32x32x16_bf16 v[8:23], v[72:75], v[48:51], v[8:23]
    ds_read_b128 v[72:75], v70 offset:6656
    v_exp_f32 v62, v62
    v_exp_f32 v63, v63
    v_cvt_pk_bf16_f32 v58, v60, v61
    v_cvt_pk_bf16_f32 v59, v62, v63
    s_waitcnt vmcnt(4)
    s_barrier
    ds_read_b32 v31, v31
    s_setprio 3
    v_exp_f32 v32, v32
    v_exp_f32 v33, v33
    s_waitcnt lgkmcnt(4)
    v_mfma_f32_32x32x16_bf16 v[8:23], v[76:79], v[56:59], v[8:23]
    ds_read_b128 v[76:79], v70 offset:7360
    v_exp_f32 v34, v34
    v_exp_f32 v35, v35
    v_cvt_pk_bf16_f32 v32, v32, v33
    v_cvt_pk_bf16_f32 v33, v34, v35
    v_exp_f32 v36, v36
    s_add_u32 m0, s77, 135168
    s_add_u32 s70, s76, 32768
    buffer_load_dwordx4 v1, s[32:35], s70 offen sc1 lds
    v_exp_f32 v37, v37
    s_waitcnt lgkmcnt(4)
    v_mfma_f32_32x32x16_bf16 v[48:63], v[64:67], v[24:27], 0
    ds_read_b128 v[64:67], v30 offset:10752
    v_exp_f32 v38, v38
    v_exp_f32 v39, v39
    s_setprio 2
    v_cvt_pk_bf16_f32 v34, v36, v37
    v_cvt_pk_bf16_f32 v35, v38, v39
    v_exp_f32 v40, v40
    v_exp_f32 v41, v41
    s_waitcnt lgkmcnt(4)
    v_mfma_f32_32x32x8_bf16 v[48:63], v[68:69], v[28:29], v[48:63]
    ds_read_b64 v[68:69], v71 offset:10752
    v_exp_f32 v42, v42
    v_exp_f32 v43, v43
    v_cvt_pk_bf16_f32 v40, v40, v41
    v_cvt_pk_bf16_f32 v41, v42, v43
    v_exp_f32 v44, v44
    v_exp_f32 v45, v45
    s_waitcnt lgkmcnt(4)
    v_mfma_f32_32x32x16_bf16 v[8:23], v[72:75], v[32:35], v[8:23]
    ds_read_b128 v[72:75], v70 offset:9344
    v_exp_f32 v46, v46
    v_exp_f32 v47, v47
    v_cvt_pk_bf16_f32 v42, v44, v45
    v_cvt_pk_bf16_f32 v43, v46, v47
    s_setprio 1
    v_exp_f32 v48, v48
    v_exp_f32 v49, v49
    s_waitcnt lgkmcnt(3)
    v_mfma_f32_32x32x16_bf16 v[8:23], v[76:79], v[40:43], v[8:23]
    ds_read_b128 v[76:79], v70 offset:10048
    v_exp_f32 v50, v50
    v_exp_f32 v51, v51
    v_cvt_pk_bf16_f32 v48, v48, v49
    v_cvt_pk_bf16_f32 v49, v50, v51
    v_exp_f32 v52, v52
    v_cmp_ne_u32 vcc, 0, v31
    s_cbranch_vccnz L_slow
    v_exp_f32 v53, v53
    s_waitcnt lgkmcnt(3)
    v_mfma_f32_32x32x16_bf16 v[32:47], v[64:67], v[24:27], 0
    ds_read_b128 v[64:67], v30 offset:13440
    v_exp_f32 v54, v54
    v_exp_f32 v55, v55
    s_setprio 0
    v_cvt_pk_bf16_f32 v50, v52, v53
    v_cvt_pk_bf16_f32 v51, v54, v55
    v_exp_f32 v56, v56
    v_exp_f32 v57, v57
    s_waitcnt lgkmcnt(3)
    v_mfma_f32_32x32x8_bf16 v[32:47], v[68:69], v[28:29], v[32:47]
    ds_read_b64 v[68:69], v71 offset:13440
    v_exp_f32 v58, v58
    v_exp_f32 v59, v59
    v_cvt_pk_bf16_f32 v56, v56, v57
    v_cvt_pk_bf16_f32 v57, v58, v59
    v_exp_f32 v60, v60
    v_exp_f32 v61, v61
    s_waitcnt lgkmcnt(3)
    v_mfma_f32_32x32x16_bf16 v[8:23], v[72:75], v[48:51], v[8:23]
    ds_read_b128 v[72:75], v70 offset:12032
    v_exp_f32 v62, v62
    v_exp_f32 v63, v63
    v_cvt_pk_bf16_f32 v58, v60, v61
    v_cvt_pk_bf16_f32 v59, v62, v63
    s_setprio 3
    v_exp_f32 v32, v32
    v_exp_f32 v33, v33
    s_waitcnt lgkmcnt(3)
    v_mfma_f32_32x32x16_bf16 v[8:23], v[76:79], v[56:59], v[8:23]
    ds_read_b128 v[76:79], v70 offset:12736
    v_exp_f32 v34, v34
    s_mul_i32 s68, s36, 196608
    v_exp_f32 v35, v35
    v_cvt_pk_bf16_f32 v32, v32, v33
    v_cvt_pk_bf16_f32 v33, v34, v35
    v_exp_f32 v36, v36
    s_lshl_b32 s70, s5, 3
    s_add_u32 s70, s70, s38
    s_mul_i32 s70, s70, 3072
    s_add_u32 s39, s70, 6291456
    s_mov_b32 exec_lo, 0x01010101
    s_mov_b32 exec_hi, 0x01010101
    buffer_load_dword a127, v1, s[32:35], s39 offen offset:0 sc1
    s_mov_b64 exec, -1
    v_exp_f32 v37, v37
    s_waitcnt lgkmcnt(3)
    v_mfma_f32_32x32x16_bf16 v[48:63], v[64:67], v[24:27], 0
    ds_read_b128 v[64:67], v30 offset:16128
    v_exp_f32 v38, v38
    v_exp_f32 v39, v39
    s_setprio 2
    v_cvt_pk_bf16_f32 v34, v36, v37
    v_cvt_pk_bf16_f32 v35, v38, v39
    v_exp_f32 v40, v40
    s_add_u32 s68, s68, 6291456
    v_exp_f32 v41, v41
    s_waitcnt lgkmcnt(3)
    v_mfma_f32_32x32x8_bf16 v[48:63], v[68:69], v[28:29], v[48:63]
    ds_read_b64 v[68:69], v71 offset:16128
    v_exp_f32 v42, v42
    v_exp_f32 v43, v43
    v_cvt_pk_bf16_f32 v40, v40, v41
    v_cvt_pk_bf16_f32 v41, v42, v43
    v_exp_f32 v44, v44
    v_exp_f32 v45, v45
    s_waitcnt lgkmcnt(3)
    v_mfma_f32_32x32x16_bf16 v[8:23], v[72:75], v[32:35], v[8:23]
    ds_read_b128 v[72:75], v70 offset:14720
    v_exp_f32 v46, v46
    s_mul_i32 s0, s63, 20
    v_exp_f32 v47, v47
    v_cvt_pk_bf16_f32 v42, v44, v45
    v_cvt_pk_bf16_f32 v43, v46, v47
    s_setprio 1
    v_exp_f32 v48, v48
    v_exp_f32 v49, v49
    s_waitcnt lgkmcnt(3)
    v_mfma_f32_32x32x16_bf16 v[8:23], v[76:79], v[40:43], v[8:23]
    ds_read_b128 v[76:79], v70 offset:15424
    v_exp_f32 v50, v50
    s_mul_i32 s1, s43, 10
    v_exp_f32 v51, v51
    v_cvt_pk_bf16_f32 v48, v48, v49
    v_cvt_pk_bf16_f32 v49, v50, v51
    v_exp_f32 v52, v52
    v_exp_f32 v53, v53
    s_waitcnt lgkmcnt(3)
    v_mfma_f32_32x32x16_bf16 v[32:47], v[64:67], v[24:27], 0
    ds_read_b128 v[64:67], v30 offset:18816
    v_exp_f32 v54, v54
    v_exp_f32 v55, v55
    s_setprio 0
    v_cvt_pk_bf16_f32 v50, v52, v53
    v_cvt_pk_bf16_f32 v51, v54, v55
    v_exp_f32 v56, v56
    s_add_u32 s0, s0, s1
    v_exp_f32 v57, v57
    s_waitcnt lgkmcnt(3)
    v_mfma_f32_32x32x8_bf16 v[32:47], v[68:69], v[28:29], v[32:47]
    ds_read_b64 v[68:69], v71 offset:18816
    v_exp_f32 v58, v58
    v_exp_f32 v59, v59
    v_cvt_pk_bf16_f32 v56, v56, v57
    v_cvt_pk_bf16_f32 v57, v58, v59
    v_exp_f32 v60, v60
    v_exp_f32 v61, v61
    s_waitcnt lgkmcnt(3)
    v_mfma_f32_32x32x16_bf16 v[8:23], v[72:75], v[48:51], v[8:23]
    ds_read_b128 v[72:75], v70 offset:17408
    v_exp_f32 v62, v62
    s_lshl_b32 s0, s0, 10
    v_exp_f32 v63, v63
    v_cvt_pk_bf16_f32 v58, v60, v61
    v_cvt_pk_bf16_f32 v59, v62, v63
    s_waitcnt vmcnt(5)
    s_barrier
    s_setprio 3
    v_exp_f32 v32, v32
    v_exp_f32 v33, v33
    s_waitcnt lgkmcnt(3)
    v_mfma_f32_32x32x16_bf16 v[8:23], v[76:79], v[56:59], v[8:23]
    ds_read_b128 v[76:79], v70 offset:18112
    v_exp_f32 v34, v34
    s_add_u32 s50, s0, s68
    v_exp_f32 v35, v35
    v_cvt_pk_bf16_f32 v32, v32, v33
    v_cvt_pk_bf16_f32 v33, v34, v35
    v_exp_f32 v36, v36
    s_cmp_ge_u32 s38, 2
    s_cselect_b32 s70, 43008, 0
    s_sub_u32 s70, s77, s70
    s_add_u32 m0, s70, 143360
    s_add_u32 s70, s76, 40960
    buffer_load_dwordx4 v1, s[32:35], s70 offen sc1 lds
    v_exp_f32 v37, v37
    s_waitcnt lgkmcnt(3)
    v_mfma_f32_32x32x16_bf16 v[48:63], v[64:67], v[24:27], 0
    ds_read_b128 v[64:67], v30 offset:21504
    v_exp_f32 v38, v38
    v_exp_f32 v39, v39
    s_setprio 2
    v_cvt_pk_bf16_f32 v34, v36, v37
    v_cvt_pk_bf16_f32 v35, v38, v39
    v_exp_f32 v40, v40
    s_add_u32 s51, s50, 4096
    v_exp_f32 v41, v41
    s_waitcnt lgkmcnt(3)
    v_mfma_f32_32x32x8_bf16 v[48:63], v[68:69], v[28:29], v[48:63]
    ds_read_b64 v[68:69], v71 offset:21504
    v_exp_f32 v42, v42
    v_exp_f32 v43, v43
    v_cvt_pk_bf16_f32 v40, v40, v41
    v_cvt_pk_bf16_f32 v41, v42, v43
    v_exp_f32 v44, v44
    v_exp_f32 v45, v45
    s_waitcnt lgkmcnt(3)
    v_mfma_f32_32x32x16_bf16 v[8:23], v[72:75], v[32:35], v[8:23]
    ds_read_b128 v[72:75], v70 offset:20096
    v_exp_f32 v46, v46
    s_add_u32 s52, s50, 8192
    v_exp_f32 v47, v47
    v_cvt_pk_bf16_f32 v42, v44, v45
    v_cvt_pk_bf16_f32 v43, v46, v47
    s_setprio 1
    v_exp_f32 v48, v48
    v_exp_f32 v49, v49
    s_waitcnt lgkmcnt(3)
    v_mfma_f32_32x32x16_bf16 v[8:23], v[76:79], v[40:43], v[8:23]
    ds_read_b128 v[76:79], v70 offset:20800
    v_exp_f32 v50, v50
    s_lshr_b32 s0, s37, 1
    v_exp_f32 v51, v51
    v_cvt_pk_bf16_f32 v48, v48, v49
    v_cvt_pk_bf16_f32 v49, v50, v51
    v_exp_f32 v52, v52
    s_mov_b32 exec_lo, 0x01010101
    s_mov_b32 exec_hi, 0x01010101
    buffer_load_dword a127, v1, s[32:35], s39 offen offset:1024 sc1
    s_mov_b64 exec, -1
    v_exp_f32 v53, v53
    s_waitcnt lgkmcnt(3)
    v_mfma_f32_32x32x16_bf16 v[32:47], v[64:67], v[24:27], 0
    ds_read_b128 v[64:67], v30 offset:24192
    v_exp_f32 v54, v54
    v_exp_f32 v55, v55
    s_setprio 0
    v_cvt_pk_bf16_f32 v50, v52, v53
    v_cvt_pk_bf16_f32 v51, v54, v55
    v_exp_f32 v56, v56
    s_mul_i32 s0, s0, 5
    v_exp_f32 v57, v57
    s_waitcnt lgkmcnt(3)
    v_mfma_f32_32x32x8_bf16 v[32:47], v[68:69], v[28:29], v[32:47]
    ds_read_b64 v[68:69], v71 offset:24192
    v_exp_f32 v58, v58
    v_exp_f32 v59, v59
    v_cvt_pk_bf16_f32 v56, v56, v57
    v_cvt_pk_bf16_f32 v57, v58, v59
    v_exp_f32 v60, v60
    v_exp_f32 v61, v61
    s_waitcnt lgkmcnt(3)
    v_mfma_f32_32x32x16_bf16 v[8:23], v[72:75], v[48:51], v[8:23]
    ds_read_b128 v[72:75], v70 offset:22784
    v_exp_f32 v62, v62
    s_mul_i32 s1, s44, 40
    v_exp_f32 v63, v63
    v_cvt_pk_bf16_f32 v58, v60, v61
    v_cvt_pk_bf16_f32 v59, v62, v63
    s_setprio 3
    v_exp_f32 v32, v32
    v_exp_f32 v33, v33
    s_waitcnt lgkmcnt(3)
    v_mfma_f32_32x32x16_bf16 v[8:23], v[76:79], v[56:59], v[8:23]
    ds_read_b128 v[76:79], v70 offset:23488
    v_exp_f32 v34, v34
    s_add_u32 s0, s0, s1
    v_exp_f32 v35, v35
    v_cvt_pk_bf16_f32 v32, v32, v33
    v_cvt_pk_bf16_f32 v33, v34, v35
    v_exp_f32 v36, v36
    s_waitcnt vmcnt(4)
    ds_write_b128 v91, a[32:35] offset:0
    v_exp_f32 v37, v37
    s_waitcnt lgkmcnt(4)
    v_mfma_f32_32x32x16_bf16 v[48:63], v[64:67], v[24:27], 0
    ds_read_b128 v[64:67], v30 offset:26880
    v_exp_f32 v38, v38
    v_exp_f32 v39, v39
    s_setprio 2
    v_cvt_pk_bf16_f32 v34, v36, v37
    v_cvt_pk_bf16_f32 v35, v38, v39
    v_exp_f32 v40, v40
    s_lshl_b32 s0, s0, 10
    v_exp_f32 v41, v41
    s_waitcnt lgkmcnt(4)
    v_mfma_f32_32x32x8_bf16 v[48:63], v[68:69], v[28:29], v[48:63]
    ds_read_b64 v[68:69], v71 offset:26880
    v_exp_f32 v42, v42
    v_exp_f32 v43, v43
    v_cvt_pk_bf16_f32 v40, v40, v41
    v_cvt_pk_bf16_f32 v41, v42, v43
    v_exp_f32 v44, v44
    ds_write_b128 v91, a[36:39] offset:9216
    v_exp_f32 v45, v45
    s_waitcnt lgkmcnt(5)
    v_mfma_f32_32x32x16_bf16 v[8:23], v[72:75], v[32:35], v[8:23]
    ds_read_b128 v[72:75], v70 offset:25472
    v_exp_f32 v46, v46
    s_add_u32 s68, s68, s0
    v_exp_f32 v47, v47
    v_cvt_pk_bf16_f32 v42, v44, v45
    v_cvt_pk_bf16_f32 v43, v46, v47
    s_setprio 1
    v_exp_f32 v48, v48
    v_exp_f32 v49, v49
    s_waitcnt lgkmcnt(5)
    v_mfma_f32_32x32x16_bf16 v[8:23], v[76:79], v[40:43], v[8:23]
    ds_read_b128 v[76:79], v70 offset:26176
    v_exp_f32 v50, v50
    s_and_b32 s1, s37, 1
    v_exp_f32 v51, v51
    v_cvt_pk_bf16_f32 v48, v48, v49
    v_cvt_pk_bf16_f32 v49, v50, v51
    v_exp_f32 v52, v52
    ds_write_b128 v91, a[40:43] offset:18432
    v_exp_f32 v53, v53
    s_waitcnt lgkmcnt(5)
    v_mfma_f32_32x32x16_bf16 v[32:47], v[64:67], v[24:27], 0
    ds_read_b128 v[64:67], v30 offset:29568
    v_exp_f32 v54, v54
    v_exp_f32 v55, v55
    s_setprio 0
    v_cvt_pk_bf16_f32 v50, v52, v53
    v_cvt_pk_bf16_f32 v51, v54, v55
    v_exp_f32 v56, v56
    s_lshl_b32 s1, s1, 2
    v_exp_f32 v57, v57
    s_waitcnt lgkmcnt(5)
    v_mfma_f32_32x32x8_bf16 v[32:47], v[68:69], v[28:29], v[32:47]
    ds_read_b64 v[68:69], v71 offset:29568
    v_exp_f32 v58, v58
    v_exp_f32 v59, v59
    v_cvt_pk_bf16_f32 v56, v56, v57
    v_cvt_pk_bf16_f32 v57, v58, v59
    v_exp_f32 v60, v60
    v_exp_f32 v61, v61
    s_waitcnt lgkmcnt(4)
    v_mfma_f32_32x32x16_bf16 v[8:23], v[72:75], v[48:51], v[8:23]
    ds_read_b128 v[72:75], v70 offset:28160
    v_exp_f32 v62, v62
    s_add_u32 s1, s1, s45
    v_exp_f32 v63, v63
    v_cvt_pk_bf16_f32 v58, v60, v61
    v_cvt_pk_bf16_f32 v59, v62, v63
    s_waitcnt vmcnt(1)
    s_waitcnt lgkmcnt(3)
    s_barrier
    s_setprio 3
    v_exp_f32 v32, v32
    v_exp_f32 v33, v33
    v_mfma_f32_32x32x16_bf16 v[8:23], v[76:79], v[56:59], v[8:23]
    ds_read_b128 v[76:79], v70 offset:28864
    v_exp_f32 v34, v34
    s_lshl_b32 s0, s1, 9
    v_exp_f32 v35, v35
    v_cvt_pk_bf16_f32 v32, v32, v33
    v_cvt_pk_bf16_f32 v33, v34, v35
    v_exp_f32 v36, v36
    s_add_u32 m0, s77, 108544
    s_add_u32 s70, s76, 49152
    buffer_load_dwordx4 v1, s[32:35], s70 offen sc1 lds
    v_exp_f32 v37, v37
    s_waitcnt lgkmcnt(3)
    v_mfma_f32_32x32x16_bf16 v[48:63], v[64:67], v[24:27], 0
    ds_read_b128 v[64:67], v30 offset:32256
    v_exp_f32 v38, v38
    v_exp_f32 v39, v39
    s_setprio 2
    v_cvt_pk_bf16_f32 v34, v36, v37
    v_cvt_pk_bf16_f32 v35, v38, v39
    v_exp_f32 v40, v40
    s_add_u32 s48, s0, s68
    v_exp_f32 v41, v41
    s_waitcnt lgkmcnt(3)
    v_mfma_f32_32x32x8_bf16 v[48:63], v[68:69], v[28:29], v[48:63]
    ds_read_b64 v[68:69], v71 offset:32256
    v_exp_f32 v42, v42
    v_exp_f32 v43, v43
    v_cvt_pk_bf16_f32 v40, v40, v41
    v_cvt_pk_bf16_f32 v41, v42, v43
    v_exp_f32 v44, v44
    ds_read_b64_tr_b16 v[96:97], v92
    ds_read_b64_tr_b16 v[98:99], v93
    v_exp_f32 v45, v45
    s_waitcnt lgkmcnt(5)
    v_mfma_f32_32x32x16_bf16 v[8:23], v[72:75], v[32:35], v[8:23]
    ds_read_b128 v[72:75], v70 offset:30848
    v_exp_f32 v46, v46
    s_lshr_b32 s0, s1, 1
    v_exp_f32 v47, v47
    v_cvt_pk_bf16_f32 v42, v44, v45
    v_cvt_pk_bf16_f32 v43, v46, v47
    s_setprio 1
    v_exp_f32 v48, v48
    v_exp_f32 v49, v49
    s_waitcnt lgkmcnt(5)
    v_mfma_f32_32x32x16_bf16 v[8:23], v[76:79], v[40:43], v[8:23]
    ds_read_b128 v[76:79], v70 offset:31552
    v_exp_f32 v50, v50
    s_lshl_b32 s0, s0, 8
    v_exp_f32 v51, v51
    v_cvt_pk_bf16_f32 v48, v48, v49
    v_cvt_pk_bf16_f32 v49, v50, v51
    v_exp_f32 v52, v52
    ds_read_b64_tr_b16 v[100:101], v120
    ds_read_b64_tr_b16 v[102:103], v121
    v_exp_f32 v53, v53
    s_waitcnt lgkmcnt(7)
    v_mfma_f32_32x32x16_bf16 v[32:47], v[64:67], v[24:27], 0
    ds_read_b128 v[64:67], v30 offset:34944
    v_exp_f32 v54, v54
    v_exp_f32 v55, v55
    s_setprio 0
    v_cvt_pk_bf16_f32 v50, v52, v53
    v_cvt_pk_bf16_f32 v51, v54, v55
    v_exp_f32 v56, v56
    s_and_b32 s1, s1, 1
    v_exp_f32 v57, v57
    s_waitcnt lgkmcnt(7)
    v_mfma_f32_32x32x8_bf16 v[32:47], v[68:69], v[28:29], v[32:47]
    ds_read_b64 v[68:69], v71 offset:34944
    v_exp_f32 v58, v58
    v_exp_f32 v59, v59
    v_cvt_pk_bf16_f32 v56, v56, v57
    v_cvt_pk_bf16_f32 v57, v58, v59
    v_exp_f32 v60, v60
    ds_read_b64_tr_b16 v[104:105], v122
    ds_read_b64_tr_b16 v[106:107], v123
    v_exp_f32 v61, v61
    s_waitcnt lgkmcnt(7)
    v_mfma_f32_32x32x16_bf16 v[8:23], v[72:75], v[48:51], v[8:23]
    ds_read_b128 v[72:75], v70 offset:33536
    v_exp_f32 v62, v62
    s_lshl_b32 s1, s1, 3
    v_exp_f32 v63, v63
    v_cvt_pk_bf16_f32 v58, v60, v61
    v_cvt_pk_bf16_f32 v59, v62, v63
    s_setprio 3
    v_exp_f32 v32, v32
    v_exp_f32 v33, v33
    s_waitcnt lgkmcnt(7)
    v_mfma_f32_32x32x16_bf16 v[8:23], v[76:79], v[56:59], v[8:23]
    ds_read_b128 v[76:79], v70 offset:34240
    v_exp_f32 v34, v34
    s_add_u32 s0, s0, s1
    v_exp_f32 v35, v35
    v_cvt_pk_bf16_f32 v32, v32, v33
    v_cvt_pk_bf16_f32 v33, v34, v35
    v_exp_f32 v36, v36
    buffer_store_dwordx4 v[96:99], v1, s[32:35], s88 offen offset:0 sc1
    v_exp_f32 v37, v37
    s_waitcnt lgkmcnt(5)
    v_mfma_f32_32x32x16_bf16 v[48:63], v[64:67], v[24:27], 0
    ds_read_b128 v[64:67], v30 offset:37632
    v_exp_f32 v38, v38
    v_exp_f32 v39, v39
    s_setprio 2
    v_cvt_pk_bf16_f32 v34, v36, v37
    v_cvt_pk_bf16_f32 v35, v38, v39
    v_exp_f32 v40, v40
    s_add_u32 s0, s0, s68
    v_exp_f32 v41, v41
    s_waitcnt lgkmcnt(5)
    v_mfma_f32_32x32x8_bf16 v[48:63], v[68:69], v[28:29], v[48:63]
    ds_read_b64 v[68:69], v71 offset:37632
    v_exp_f32 v42, v42
    v_exp_f32 v43, v43
    v_cvt_pk_bf16_f32 v40, v40, v41
    v_cvt_pk_bf16_f32 v41, v42, v43
    v_exp_f32 v44, v44
    v_exp_f32 v45, v45
    s_waitcnt lgkmcnt(3)
    v_mfma_f32_32x32x16_bf16 v[8:23], v[72:75], v[32:35], v[8:23]
    ds_read_b128 v[72:75], v70 offset:36224
    v_exp_f32 v46, v46
    s_add_u32 s49, s0, 4096
    v_exp_f32 v47, v47
    v_cvt_pk_bf16_f32 v42, v44, v45
    v_cvt_pk_bf16_f32 v43, v46, v47
    s_setprio 1
    v_exp_f32 v48, v48
    v_exp_f32 v49, v49
    s_waitcnt lgkmcnt(3)
    v_mfma_f32_32x32x16_bf16 v[8:23], v[76:79], v[40:43], v[8:23]
    ds_read_b128 v[76:79], v70 offset:36928
    v_exp_f32 v50, v50
    s_lshr_b32 s0, s37, 1
    v_exp_f32 v51, v51
    v_cvt_pk_bf16_f32 v48, v48, v49
    v_cvt_pk_bf16_f32 v49, v50, v51
    v_exp_f32 v52, v52
    buffer_store_dwordx4 v[100:103], v1, s[32:35], s88 offen offset:2048 sc1
    v_exp_f32 v53, v53
    s_waitcnt lgkmcnt(3)
    v_mfma_f32_32x32x16_bf16 v[32:47], v[64:67], v[24:27], 0
    ds_read_b128 v[64:67], v30 offset:40320
    v_exp_f32 v54, v54
    v_exp_f32 v55, v55
    s_setprio 0
    v_cvt_pk_bf16_f32 v50, v52, v53
    v_cvt_pk_bf16_f32 v51, v54, v55
    v_exp_f32 v56, v56
    s_mul_i32 s0, s0, 5
    v_exp_f32 v57, v57
    s_waitcnt lgkmcnt(3)
    v_mfma_f32_32x32x8_bf16 v[32:47], v[68:69], v[28:29], v[32:47]
    ds_read_b64 v[68:69], v71 offset:40320
    v_exp_f32 v58, v58
    v_exp_f32 v59, v59
    v_cvt_pk_bf16_f32 v56, v56, v57
    v_cvt_pk_bf16_f32 v57, v58, v59
    v_exp_f32 v60, v60
    buffer_store_dwordx4 v[104:107], v1, s[32:35], s89 offen offset:0 sc1
    v_mov_b32 v108, s42
    v_mov_b32 v109, s42
    v_mov_b32 v110, s42
    v_mov_b32 v111, s42
    s_nop 1
    v_mfma_f32_16x16x32_bf16 v[112:115], v[96:99], v[108:111], 0
    v_mfma_f32_16x16x32_bf16 v[112:115], v[100:103], v[108:111], v[112:115]
    s_cmp_lg_u32 s44, 0
    s_cbranch_scc1 L_tm_17
    v_mfma_f32_16x16x32_bf16 v[112:115], v[104:107], v[108:111], v[112:115]
L_tm_17:
    v_exp_f32 v61, v61
    s_waitcnt lgkmcnt(3)
    v_mfma_f32_32x32x16_bf16 v[8:23], v[72:75], v[48:51], v[8:23]
    ds_read_b128 v[72:75], v70 offset:38912
    v_exp_f32 v62, v62
    s_mul_i32 s1, s63, 20
    v_exp_f32 v63, v63
    v_cvt_pk_bf16_f32 v58, v60, v61
    v_cvt_pk_bf16_f32 v59, v62, v63
    s_waitcnt vmcnt(3)
    s_barrier
    s_setprio 3
    v_exp_f32 v32, v32
    v_exp_f32 v33, v33
    s_waitcnt lgkmcnt(3)
    v_mfma_f32_32x32x16_bf16 v[8:23], v[76:79], v[56:59], v[8:23]
    ds_read_b128 v[76:79], v70 offset:39616
    v_exp_f32 v34, v34
    s_add_u32 s0, s0, s1
    v_exp_f32 v35, v35
    v_cvt_pk_bf16_f32 v32, v32, v33
    v_cvt_pk_bf16_f32 v33, v34, v35
    v_exp_f32 v36, v36
    s_add_u32 m0, s77, 116736
    s_add_u32 s70, s76, 57344
    buffer_load_dwordx4 v1, s[32:35], s70 offen sc1 lds
    v_exp_f32 v37, v37
    s_waitcnt lgkmcnt(3)
    v_mfma_f32_32x32x16_bf16 v[48:63], v[64:67], v[24:27], 0
    ds_read_b128 v[64:67], v30 offset:0
    v_exp_f32 v38, v38
    v_exp_f32 v39, v39
    s_setprio 2
    v_cvt_pk_bf16_f32 v34, v36, v37
    v_cvt_pk_bf16_f32 v35, v38, v39
    v_exp_f32 v40, v40
    s_lshl_b32 s0, s0, 10
    v_exp_f32 v41, v41
    s_waitcnt lgkmcnt(3)
    v_mfma_f32_32x32x8_bf16 v[48:63], v[68:69], v[28:29], v[48:63]
    ds_read_b64 v[68:69], v71 offset:0
    v_exp_f32 v42, v42
    v_exp_f32 v43, v43
    v_cvt_pk_bf16_f32 v40, v40, v41
    v_cvt_pk_bf16_f32 v41, v42, v43
    v_exp_f32 v44, v44
    s_add_u32 m0, s77, 124928
    s_add_u32 s70, s76, 65536
    buffer_load_dwordx4 v1, s[32:35], s70 offen sc1 lds
    v_exp_f32 v45, v45
    s_waitcnt lgkmcnt(3)
    v_mfma_f32_32x32x16_bf16 v[8:23], v[72:75], v[32:35], v[8:23]
    ds_read_b128 v[72:75], v70 offset:41600
    v_exp_f32 v46, v46
    s_add_u32 s68, s0, s6
    v_exp_f32 v47, v47
    v_cvt_pk_bf16_f32 v42, v44, v45
    v_cvt_pk_bf16_f32 v43, v46, v47
    s_setprio 1
    v_exp_f32 v48, v48
    v_exp_f32 v49, v49
    s_waitcnt lgkmcnt(3)
    v_mfma_f32_32x32x16_bf16 v[8:23], v[76:79], v[40:43], v[8:23]
    ds_read_b128 v[76:79], v70 offset:42304
    v_exp_f32 v50, v50
    s_and_b32 s1, s37, 1
    v_exp_f32 v51, v51
    v_cvt_pk_bf16_f32 v48, v48, v49
    v_cvt_pk_bf16_f32 v49, v50, v51
    v_exp_f32 v52, v52
    s_mov_b64 exec, 0x10001
    s_mov_b32 exec_hi, 0x10001
    buffer_store_dwordx4 v[112:115], v0, s[32:35], s62 offen sc1
    s_mov_b64 exec, -1
    v_exp_f32 v53, v53
    s_waitcnt lgkmcnt(3)
    v_mfma_f32_32x32x16_bf16 v[32:47], v[64:67], v[24:27], 0
    ds_read_b128 v[64:67], v30 offset:2688
    v_exp_f32 v54, v54
    v_exp_f32 v55, v55
    s_setprio 0
    v_cvt_pk_bf16_f32 v50, v52, v53
    v_cvt_pk_bf16_f32 v51, v54, v55
    v_exp_f32 v56, v56
    s_lshl_b32 s1, s1, 1
    v_exp_f32 v57, v57
    s_waitcnt lgkmcnt(3)
    v_mfma_f32_32x32x8_bf16 v[32:47], v[68:69], v[28:29], v[32:47]
    ds_read_b64 v[68:69], v71 offset:2688
    v_exp_f32 v58, v58
    v_exp_f32 v59, v59
    v_cvt_pk_bf16_f32 v56, v56, v57
    v_cvt_pk_bf16_f32 v57, v58, v59
    v_exp_f32 v60, v60
    s_lshl_b32 s70, s43, 6
    s_add_u32 s70, s70, s67
    buffer_load_dwordx2 v[2:3], v94, s[8:11], s70 offen offset:0
    v_exp_f32 v61, v61
    s_waitcnt lgkmcnt(3)
    v_mfma_f32_32x32x16_bf16 v[8:23], v[72:75], v[48:51], v[8:23]
    ds_read_b128 v[72:75], v70 offset:1280
    v_exp_f32 v62, v62
    s_add_u32 s0, s1, s43
    v_exp_f32 v63, v63
    v_cvt_pk_bf16_f32 v58, v60, v61
    v_cvt_pk_bf16_f32 v59, v62, v63
    s_setprio 3
    v_exp_f32 v32, v32
    v_exp_f32 v33, v33
    s_waitcnt lgkmcnt(3)
    v_mfma_f32_32x32x16_bf16 v[8:23], v[76:79], v[56:59], v[8:23]
    ds_read_b128 v[76:79], v70 offset:1984
    v_exp_f32 v34, v34
    s_lshl_b32 s0, s0, 10
    v_exp_f32 v35, v35
    v_cvt_pk_bf16_f32 v32, v32, v33
    v_cvt_pk_bf16_f32 v33, v34, v35
    v_exp_f32 v36, v36
    s_lshl_b32 s70, s43, 6
    s_add_u32 s70, s70, s67
    buffer_load_dwordx2 v[4:5], v94, s[8:11], s70 offen offset:32
    v_exp_f32 v37, v37
    s_waitcnt lgkmcnt(3)
    v_mfma_f32_32x32x16_bf16 v[48:63], v[64:67], v[24:27], 0
    ds_read_b128 v[64:67], v30 offset:5376
    v_exp_f32 v38, v38
    v_exp_f32 v39, v39
    s_setprio 2
    v_cvt_pk_bf16_f32 v34, v36, v37
    v_cvt_pk_bf16_f32 v35, v38, v39
    v_exp_f32 v40, v40
    s_add_u32 s53, s0, s68
    v_exp_f32 v41, v41
    s_waitcnt lgkmcnt(3)
    v_mfma_f32_32x32x8_bf16 v[48:63], v[68:69], v[28:29], v[48:63]
    ds_read_b64 v[68:69], v71 offset:5376
    v_exp_f32 v42, v42
    v_exp_f32 v43, v43
    v_cvt_pk_bf16_f32 v40, v40, v41
    v_cvt_pk_bf16_f32 v41, v42, v43
    v_exp_f32 v44, v44
    buffer_load_dwordx2 v[6:7], v94, s[8:11], s67 offen offset:128
    v_exp_f32 v45, v45
    s_waitcnt lgkmcnt(3)
    v_mfma_f32_32x32x16_bf16 v[8:23], v[72:75], v[32:35], v[8:23]
    ds_read_b128 v[72:75], v70 offset:3968
    v_exp_f32 v46, v46
    s_lshl_b32 s1, s1, 8
    v_exp_f32 v47, v47
    v_cvt_pk_bf16_f32 v42, v44, v45
    v_cvt_pk_bf16_f32 v43, v46, v47
    s_setprio 1
    v_exp_f32 v48, v48
    v_exp_f32 v49, v49
    s_waitcnt lgkmcnt(3)
    v_mfma_f32_32x32x16_bf16 v[8:23], v[76:79], v[40:43], v[8:23]
    ds_read_b128 v[76:79], v70 offset:4672
    v_exp_f32 v50, v50
    s_add_u32 s0, s1, s68
    v_exp_f32 v51, v51
    v_cvt_pk_bf16_f32 v48, v48, v49
    v_cvt_pk_bf16_f32 v49, v50, v51
    v_exp_f32 v52, v52
    v_lshlrev_b32 v31, 15, v0
    s_mov_b64 exec, 15
    buffer_load_dword a127, v31, s[32:35], s3 offen sc1
    s_mov_b64 exec, -1
    v_exp_f32 v53, v53
    s_waitcnt lgkmcnt(3)
    v_mfma_f32_32x32x16_bf16 v[32:47], v[64:67], v[24:27], 0
    ds_read_b128 v[64:67], v30 offset:8064
    v_exp_f32 v54, v54
    v_exp_f32 v55, v55
    s_setprio 0
    v_cvt_pk_bf16_f32 v50, v52, v53
    v_cvt_pk_bf16_f32 v51, v54, v55
    v_exp_f32 v56, v56
    s_add_u32 s54, s0, 4096
    v_exp_f32 v57, v57
    s_waitcnt lgkmcnt(3)
    v_mfma_f32_32x32x8_bf16 v[32:47], v[68:69], v[28:29], v[32:47]
    ds_read_b64 v[68:69], v71 offset:8064
    v_exp_f32 v58, v58
    v_exp_f32 v59, v59
    v_cvt_pk_bf16_f32 v56, v56, v57
    v_cvt_pk_bf16_f32 v57, v58, v59
    v_exp_f32 v60, v60
    v_exp_f32 v61, v61
    s_waitcnt lgkmcnt(3)
    v_mfma_f32_32x32x16_bf16 v[8:23], v[72:75], v[48:51], v[8:23]
    ds_read_b128 v[72:75], v70 offset:6656
    v_exp_f32 v62, v62
    s_lshr_b32 s0, s37, 1
    v_exp_f32 v63, v63
    v_cvt_pk_bf16_f32 v58, v60, v61
    v_cvt_pk_bf16_f32 v59, v62, v63
    s_waitcnt vmcnt(6)
    s_waitcnt vmcnt(4)
    s_barrier
    s_setprio 3
    v_exp_f32 v32, v32
    v_exp_f32 v33, v33
    s_waitcnt lgkmcnt(3)
    v_mfma_f32_32x32x16_bf16 v[8:23], v[76:79], v[56:59], v[8:23]
    ds_read_b128 v[76:79], v70 offset:7360
    v_exp_f32 v34, v34
    s_lshl_b32 s0, s0, 8
    v_exp_f32 v35, v35
    v_cvt_pk_bf16_f32 v32, v32, v33
    v_cvt_pk_bf16_f32 v33, v34, v35
    v_exp_f32 v36, v36
    s_add_u32 m0, s77, 133120
    s_add_u32 s70, s76, 73728
    buffer_load_dwordx4 v1, s[32:35], s70 offen sc1 lds
    v_exp_f32 v37, v37
    s_waitcnt lgkmcnt(3)
    v_mfma_f32_32x32x16_bf16 v[48:63], v[64:67], v[24:27], 0
    ds_read_b128 v[64:67], v30 offset:10752
    v_exp_f32 v38, v38
    v_exp_f32 v39, v39
    s_setprio 2
    v_cvt_pk_bf16_f32 v34, v36, v37
    v_cvt_pk_bf16_f32 v35, v38, v39
    v_exp_f32 v40, v40
    s_lshl_b32 s1, s1, 1
    v_exp_f32 v41, v41
    s_waitcnt lgkmcnt(3)
    v_mfma_f32_32x32x8_bf16 v[48:63], v[68:69], v[28:29], v[48:63]
    ds_read_b64 v[68:69], v71 offset:10752
    v_exp_f32 v42, v42
    v_exp_f32 v43, v43
    v_cvt_pk_bf16_f32 v40, v40, v41
    v_cvt_pk_bf16_f32 v41, v42, v43
    v_exp_f32 v44, v44
    s_getreg_b32 s71, hwreg(HW_REG_XCC_ID)
    s_and_b32 s71, s71, 15
    s_lshl_b32 s70, s5, 7
    s_add_u32 s70, s70, 16384
    s_cmp_eq_u32 s38, 0
    s_cselect_b32 s70, s70, 0x7f000000
    v_mov_b32 v120, s40
    v_mov_b32 v121, s41
    v_mov_b32 v122, s71
    s_mov_b64 exec, 1
    buffer_store_dwordx3 v[120:122], off, s[32:35], s70 sc1
    s_mov_b64 exec, -1
    v_exp_f32 v45, v45
    s_waitcnt lgkmcnt(3)
    v_mfma_f32_32x32x16_bf16 v[8:23], v[72:75], v[32:35], v[8:23]
    ds_read_b128 v[72:75], v70 offset:9344
    v_exp_f32 v46, v46
    s_add_u32 s0, s0, s1
    v_exp_f32 v47, v47
    v_cvt_pk_bf16_f32 v42, v44, v45
    v_cvt_pk_bf16_f32 v43, v46, v47
    s_setprio 1
    v_exp_f32 v48, v48
    v_exp_f32 v49, v49
    s_waitcnt lgkmcnt(3)
    v_mfma_f32_32x32x16_bf16 v[8:23], v[76:79], v[40:43], v[8:23]
    ds_read_b128 v[76:79], v70 offset:10048
    v_exp_f32 v50, v50
    s_lshl_b32 s1, s43, 3
    v_exp_f32 v51, v51
    v_cvt_pk_bf16_f32 v48, v48, v49
    v_cvt_pk_bf16_f32 v49, v50, v51
    v_exp_f32 v52, v52
    s_mov_b32 exec_lo, 0x01010101
    s_mov_b32 exec_hi, 0x01010101
    buffer_load_dword a127, v1, s[32:35], s39 offen offset:2048 sc1
    s_mov_b64 exec, -1
    v_exp_f32 v53, v53
    s_waitcnt lgkmcnt(3)
    v_mfma_f32_32x32x16_bf16 v[32:47], v[64:67], v[24:27], 0
    ds_read_b128 v[64:67], v30 offset:13440
    v_exp_f32 v54, v54
    v_exp_f32 v55, v55
    s_setprio 0
    v_cvt_pk_bf16_f32 v50, v52, v53
    v_cvt_pk_bf16_f32 v51, v54, v55
    v_exp_f32 v56, v56
    s_add_u32 s0, s0, s1
    v_exp_f32 v57, v57
    s_waitcnt lgkmcnt(3)
    v_mfma_f32_32x32x8_bf16 v[32:47], v[68:69], v[28:29], v[32:47]
    ds_read_b64 v[68:69], v71 offset:13440
    v_exp_f32 v58, v58
    v_exp_f32 v59, v59
    v_cvt_pk_bf16_f32 v56, v56, v57
    v_cvt_pk_bf16_f32 v57, v58, v59
    v_exp_f32 v60, v60
    v_exp_f32 v61, v61
    s_waitcnt lgkmcnt(3)
    v_mfma_f32_32x32x16_bf16 v[8:23], v[72:75], v[48:51], v[8:23]
    ds_read_b128 v[72:75], v70 offset:12032
    v_exp_f32 v62, v62
    s_lshl_b32 s1, s63, 11
    v_exp_f32 v63, v63
    v_cvt_pk_bf16_f32 v58, v60, v61
    v_cvt_pk_bf16_f32 v59, v62, v63
    s_setprio 3
    v_exp_f32 v32, v32
    v_exp_f32 v33, v33
    s_waitcnt lgkmcnt(3)
    v_mfma_f32_32x32x16_bf16 v[8:23], v[76:79], v[56:59], v[8:23]
    ds_read_b128 v[76:79], v70 offset:12736
    v_exp_f32 v34, v34
    s_add_u32 s0, s0, s1
    v_exp_f32 v35, v35
    v_cvt_pk_bf16_f32 v32, v32, v33
    v_cvt_pk_bf16_f32 v33, v34, v35
    v_exp_f32 v36, v36
    v_exp_f32 v37, v37
    s_waitcnt lgkmcnt(3)
    v_mfma_f32_32x32x16_bf16 v[48:63], v[64:67], v[24:27], 0
    ds_read_b128 v[64:67], v30 offset:16128
    v_exp_f32 v38, v38
    v_exp_f32 v39, v39
    s_setprio 2
    v_cvt_pk_bf16_f32 v34, v36, v37
    v_cvt_pk_bf16_f32 v35, v38, v39
    v_exp_f32 v40, v40
    s_add_u32 s0, s0, s6
    v_exp_f32 v41, v41
    s_waitcnt lgkmcnt(3)
    v_mfma_f32_32x32x8_bf16 v[48:63], v[68:69], v[28:29], v[48:63]
    ds_read_b64 v[68:69], v71 offset:16128
    v_exp_f32 v42, v42
    v_exp_f32 v43, v43
    v_cvt_pk_bf16_f32 v40, v40, v41
    v_cvt_pk_bf16_f32 v41, v42, v43
    v_exp_f32 v44, v44
    v_exp_f32 v45, v45
    s_waitcnt lgkmcnt(3)
    v_mfma_f32_32x32x16_bf16 v[8:23], v[72:75], v[32:35], v[8:23]
    ds_read_b128 v[72:75], v70 offset:14720
    v_exp_f32 v46, v46
    s_add_u32 s55, s0, 81920
    v_exp_f32 v47, v47
    v_cvt_pk_bf16_f32 v42, v44, v45
    v_cvt_pk_bf16_f32 v43, v46, v47
    s_setprio 1
    v_exp_f32 v48, v48
    v_exp_f32 v49, v49
    s_waitcnt lgkmcnt(3)
    v_mfma_f32_32x32x16_bf16 v[8:23], v[76:79], v[40:43], v[8:23]
    ds_read_b128 v[76:79], v70 offset:15424
    v_exp_f32 v50, v50
    s_mul_i32 s68, s36, 196608
    v_exp_f32 v51, v51
    v_cvt_pk_bf16_f32 v48, v48, v49
    v_cvt_pk_bf16_f32 v49, v50, v51
    v_exp_f32 v52, v52
    v_exp_f32 v53, v53
    s_waitcnt lgkmcnt(3)
    v_mfma_f32_32x32x16_bf16 v[32:47], v[64:67], v[24:27], 0
    ds_read_b128 v[64:67], v30 offset:18816
    v_exp_f32 v54, v54
    v_exp_f32 v55, v55
    s_setprio 0
    v_cvt_pk_bf16_f32 v50, v52, v53
    v_cvt_pk_bf16_f32 v51, v54, v55
    v_exp_f32 v56, v56
    s_add_u32 s68, s68, 6291456
    v_exp_f32 v57, v57
    s_waitcnt lgkmcnt(3)
    v_mfma_f32_32x32x8_bf16 v[32:47], v[68:69], v[28:29], v[32:47]
    ds_read_b64 v[68:69], v71 offset:18816
    v_exp_f32 v58, v58
    v_exp_f32 v59, v59
    v_cvt_pk_bf16_f32 v56, v56, v57
    v_cvt_pk_bf16_f32 v57, v58, v59
    v_exp_f32 v60, v60
    v_exp_f32 v61, v61
    s_waitcnt lgkmcnt(3)
    v_mfma_f32_32x32x16_bf16 v[8:23], v[72:75], v[48:51], v[8:23]
    ds_read_b128 v[72:75], v70 offset:17408
    v_exp_f32 v62, v62
    s_mul_i32 s0, s38, 6144
    v_exp_f32 v63, v63
    v_cvt_pk_bf16_f32 v58, v60, v61
    v_cvt_pk_bf16_f32 v59, v62, v63
    s_waitcnt vmcnt(2)
    s_barrier
    s_setprio 3
    v_exp_f32 v32, v32
    v_exp_f32 v33, v33
    s_waitcnt lgkmcnt(3)
    v_mfma_f32_32x32x16_bf16 v[8:23], v[76:79], v[56:59], v[8:23]
    ds_read_b128 v[76:79], v70 offset:18112
    v_exp_f32 v34, v34
    s_add_u32 s66, s0, s68
    v_exp_f32 v35, v35
    v_cvt_pk_bf16_f32 v32, v32, v33
    v_cvt_pk_bf16_f32 v33, v34, v35
    v_exp_f32 v36, v36
    s_cmp_ge_u32 s38, 4
    s_cselect_b32 s70, 43008, 0
    s_sub_u32 s70, s77, s70
    s_add_u32 m0, s70, 141312
    s_add_u32 s70, s76, 81920
    buffer_load_dwordx4 v1, s[32:35], s70 offen sc1 lds
    v_exp_f32 v37, v37
    s_waitcnt lgkmcnt(3)
    v_mfma_f32_32x32x16_bf16 v[48:63], v[64:67], v[24:27], 0
    ds_read_b128 v[64:67], v30 offset:21504
    v_exp_f32 v38, v38
    v_exp_f32 v39, v39
    s_setprio 2
    v_cvt_pk_bf16_f32 v34, v36, v37
    v_cvt_pk_bf16_f32 v35, v38, v39
    v_exp_f32 v40, v40
    s_mul_i32 s0, s44, 48
    v_exp_f32 v41, v41
    s_waitcnt lgkmcnt(3)
    v_mfma_f32_32x32x8_bf16 v[48:63], v[68:69], v[28:29], v[48:63]
    ds_read_b64 v[68:69], v71 offset:21504
    v_exp_f32 v42, v42
    v_exp_f32 v43, v43
    v_cvt_pk_bf16_f32 v40, v40, v41
    v_cvt_pk_bf16_f32 v41, v42, v43
    v_exp_f32 v44, v44
    v_and_b32 v84, 31, v0
    s_lshl_b32 s70, s38, 5
    v_add_u32 v84, s70, v84
    v_lshlrev_b32 v84, 7, v84
    v_add_u32 v84, 16384, v84
    buffer_load_dwordx2 v[80:81], v84, s[32:35], 0 offen sc1
    v_exp_f32 v45, v45
    s_waitcnt lgkmcnt(3)
    v_mfma_f32_32x32x16_bf16 v[8:23], v[72:75], v[32:35], v[8:23]
    ds_read_b128 v[72:75], v70 offset:20096
    v_exp_f32 v46, v46
    s_mul_i32 s1, s37, 6
    v_exp_f32 v47, v47
    v_cvt_pk_bf16_f32 v42, v44, v45
    v_cvt_pk_bf16_f32 v43, v46, v47
    s_setprio 1
    v_exp_f32 v48, v48
    v_exp_f32 v49, v49
    s_waitcnt lgkmcnt(3)
    v_mfma_f32_32x32x16_bf16 v[8:23], v[76:79], v[40:43], v[8:23]
    ds_read_b128 v[76:79], v70 offset:20800
    v_exp_f32 v50, v50
    s_add_u32 s0, s0, s1
    v_exp_f32 v51, v51
    v_cvt_pk_bf16_f32 v48, v48, v49
    v_cvt_pk_bf16_f32 v49, v50, v51
    v_exp_f32 v52, v52
    v_exp_f32 v53, v53
    s_waitcnt lgkmcnt(3)
    v_mfma_f32_32x32x16_bf16 v[32:47], v[64:67], v[24:27], 0
    ds_read_b128 v[64:67], v30 offset:24192
    v_exp_f32 v54, v54
    v_exp_f32 v55, v55
    s_setprio 0
    v_cvt_pk_bf16_f32 v50, v52, v53
    v_cvt_pk_bf16_f32 v51, v54, v55
    v_exp_f32 v56, v56
    s_lshl_b32 s0, s0, 10
    v_exp_f32 v57, v57
    s_waitcnt lgkmcnt(3)
    v_mfma_f32_32x32x8_bf16 v[32:47], v[68:69], v[28:29], v[32:47]
    ds_read_b64 v[68:69], v71 offset:24192
    v_exp_f32 v58, v58
    v_exp_f32 v59, v59
    v_cvt_pk_bf16_f32 v56, v56, v57
    v_cvt_pk_bf16_f32 v57, v58, v59
    v_exp_f32 v60, v60
    v_exp_f32 v61, v61
    s_waitcnt lgkmcnt(3)
    v_mfma_f32_32x32x16_bf16 v[8:23], v[72:75], v[48:51], v[8:23]
    ds_read_b128 v[72:75], v70 offset:22784
    v_exp_f32 v62, v62
    s_add_u32 s68, s68, s0
    v_exp_f32 v63, v63
    v_cvt_pk_bf16_f32 v58, v60, v61
    v_cvt_pk_bf16_f32 v59, v62, v63
    s_setprio 3
    v_exp_f32 v32, v32
    v_exp_f32 v33, v33
    s_waitcnt lgkmcnt(3)
    v_mfma_f32_32x32x16_bf16 v[8:23], v[76:79], v[56:59], v[8:23]
    ds_read_b128 v[76:79], v70 offset:23488
    v_exp_f32 v34, v34
    s_lshl_b32 s0, s45, 10
    v_exp_f32 v35, v35
    v_cvt_pk_bf16_f32 v32, v32, v33
    v_cvt_pk_bf16_f32 v33, v34, v35
    v_exp_f32 v36, v36
    v_exp_f32 v37, v37
    s_waitcnt lgkmcnt(3)
    v_mfma_f32_32x32x16_bf16 v[48:63], v[64:67], v[24:27], 0
    ds_read_b128 v[64:67], v30 offset:26880
    v_exp_f32 v38, v38
    v_exp_f32 v39, v39
    s_setprio 2
    v_cvt_pk_bf16_f32 v34, v36, v37
    v_cvt_pk_bf16_f32 v35, v38, v39
    v_exp_f32 v40, v40
    s_add_u32 s64, s0, s68
    v_exp_f32 v41, v41
    s_waitcnt lgkmcnt(3)
    v_mfma_f32_32x32x8_bf16 v[48:63], v[68:69], v[28:29], v[48:63]
    ds_read_b64 v[68:69], v71 offset:26880
    v_exp_f32 v42, v42
    v_exp_f32 v43, v43
    v_cvt_pk_bf16_f32 v40, v40, v41
    v_cvt_pk_bf16_f32 v41, v42, v43
    v_exp_f32 v44, v44
    buffer_load_dwordx2 v[80:81], v84, s[32:35], 0 offen sc1
    v_exp_f32 v45, v45
    s_waitcnt lgkmcnt(3)
    v_mfma_f32_32x32x16_bf16 v[8:23], v[72:75], v[32:35], v[8:23]
    ds_read_b128 v[72:75], v70 offset:25472
    v_exp_f32 v46, v46
    s_lshl_b32 s0, s45, 9
    v_exp_f32 v47, v47
    v_cvt_pk_bf16_f32 v42, v44, v45
    v_cvt_pk_bf16_f32 v43, v46, v47
    s_setprio 1
    v_exp_f32 v48, v48
    v_exp_f32 v49, v49
    s_waitcnt lgkmcnt(3)
    v_mfma_f32_32x32x16_bf16 v[8:23], v[76:79], v[40:43], v[8:23]
    ds_read_b128 v[76:79], v70 offset:26176
    v_exp_f32 v50, v50
    s_add_u32 s0, s0, s68
    v_exp_f32 v51, v51
    v_cvt_pk_bf16_f32 v48, v48, v49
    v_cvt_pk_bf16_f32 v49, v50, v51
    v_exp_f32 v52, v52
    v_exp_f32 v53, v53
    s_waitcnt lgkmcnt(3)
    v_mfma_f32_32x32x16_bf16 v[32:47], v[64:67], v[24:27], 0
    ds_read_b128 v[64:67], v30 offset:29568
    v_exp_f32 v54, v54
    v_exp_f32 v55, v55
    s_setprio 0
    v_cvt_pk_bf16_f32 v50, v52, v53
    v_cvt_pk_bf16_f32 v51, v54, v55
    v_exp_f32 v56, v56
    s_add_u32 s65, s0, 4096
    v_exp_f32 v57, v57
    s_waitcnt lgkmcnt(3)
    v_mfma_f32_32x32x8_bf16 v[32:47], v[68:69], v[28:29], v[32:47]
    ds_read_b64 v[68:69], v71 offset:29568
    v_exp_f32 v58, v58
    v_exp_f32 v59, v59
    v_cvt_pk_bf16_f32 v56, v56, v57
    v_cvt_pk_bf16_f32 v57, v58, v59
    v_exp_f32 v60, v60
    v_exp_f32 v61, v61
    s_waitcnt lgkmcnt(3)
    v_mfma_f32_32x32x16_bf16 v[8:23], v[72:75], v[48:51], v[8:23]
    ds_read_b128 v[72:75], v70 offset:28160
    v_exp_f32 v62, v62
    v_exp_f32 v63, v63
    v_cvt_pk_bf16_f32 v58, v60, v61
    v_cvt_pk_bf16_f32 v59, v62, v63
    s_waitcnt vmcnt(2)
    s_waitcnt vmcnt(0)
    v_cmp_ne_u64 vcc, s[40:41], v[80:81]
    s_cbranch_vccz L_ok_18
    s_mov_b32 s79, 0x200000
L_poll_19:
    buffer_load_dwordx2 v[80:81], v84, s[32:35], 0 offen sc1
    s_sub_u32 s79, s79, 1
    s_cbranch_scc1 L_poll_19_d
    s_waitcnt vmcnt(0)
    v_cmp_ne_u64 vcc, s[40:41], v[80:81]
    s_cbranch_vccnz L_poll_19
L_poll_19_d:
L_ok_18:
    s_barrier
    s_setprio 3
    v_exp_f32 v32, v32
    v_exp_f32 v33, v33
    s_waitcnt lgkmcnt(3)
    v_mfma_f32_32x32x16_bf16 v[8:23], v[76:79], v[56:59], v[8:23]
    ds_read_b128 v[76:79], v70 offset:28864
    v_exp_f32 v34, v34
    v_exp_f32 v35, v35
    v_cvt_pk_bf16_f32 v32, v32, v33
    v_cvt_pk_bf16_f32 v33, v34, v35
    v_exp_f32 v36, v36
    v_and_b32 v86, 7, v0
    v_lshlrev_b32 v86, 7, v86
    s_lshl_b32 s70, s36, 10
    s_add_u32 s70, s70, 16384
    buffer_load_dword v87, v86, s[32:35], s70 offen offset:8 sc1
    v_exp_f32 v37, v37
    s_waitcnt lgkmcnt(3)
    v_mfma_f32_32x32x16_bf16 v[48:63], v[64:67], v[24:27], 0
    ds_read_b128 v[64:67], v30 offset:32256
    v_exp_f32 v38, v38
    v_exp_f32 v39, v39
    s_setprio 2
    v_cvt_pk_bf16_f32 v34, v36, v37
    v_cvt_pk_bf16_f32 v35, v38, v39
    v_exp_f32 v40, v40
    v_exp_f32 v41, v41
    s_waitcnt lgkmcnt(3)
    v_mfma_f32_32x32x8_bf16 v[48:63], v[68:69], v[28:29], v[48:63]
    ds_read_b64 v[68:69], v71 offset:32256
    v_exp_f32 v42, v42
    v_exp_f32 v43, v43
    v_cvt_pk_bf16_f32 v40, v40, v41
    v_cvt_pk_bf16_f32 v41, v42, v43
    v_exp_f32 v44, v44
    s_add_u32 m0, s77, 106496
    s_add_u32 s70, s76, 90112
    buffer_load_dwordx4 v1, s[32:35], s70 offen sc1 lds
    v_exp_f32 v45, v45
    s_waitcnt lgkmcnt(3)
    v_mfma_f32_32x32x16_bf16 v[8:23], v[72:75], v[32:35], v[8:23]
    ds_read_b128 v[72:75], v70 offset:30848
    v_exp_f32 v46, v46
    v_exp_f32 v47, v47
    v_cvt_pk_bf16_f32 v42, v44, v45
    v_cvt_pk_bf16_f32 v43, v46, v47
    s_setprio 1
    v_exp_f32 v48, v48
    v_exp_f32 v49, v49
    s_waitcnt lgkmcnt(3)
    v_mfma_f32_32x32x16_bf16 v[8:23], v[76:79], v[40:43], v[8:23]
    ds_read_b128 v[76:79], v70 offset:31552
    v_exp_f32 v50, v50
    v_exp_f32 v51, v51
    v_cvt_pk_bf16_f32 v48, v48, v49
    v_cvt_pk_bf16_f32 v49, v50, v51
    v_exp_f32 v52, v52
    s_add_u32 m0, s77, 114688
    s_add_u32 s70, s76, 98304
    buffer_load_dwordx4 v1, s[32:35], s70 offen sc1 lds
    v_exp_f32 v53, v53
    s_waitcnt lgkmcnt(3)
    v_mfma_f32_32x32x16_bf16 v[32:47], v[64:67], v[24:27], 0
    ds_read_b128 v[64:67], v30 offset:34944
    v_exp_f32 v54, v54
    v_exp_f32 v55, v55
    s_setprio 0
    v_cvt_pk_bf16_f32 v50, v52, v53
    v_cvt_pk_bf16_f32 v51, v54, v55
    v_exp_f32 v56, v56
    v_exp_f32 v57, v57
    s_waitcnt lgkmcnt(3)
    v_mfma_f32_32x32x8_bf16 v[32:47], v[68:69], v[28:29], v[32:47]
    ds_read_b64 v[68:69], v71 offset:34944
    v_exp_f32 v58, v58
    v_exp_f32 v59, v59
    v_cvt_pk_bf16_f32 v56, v56, v57
    v_cvt_pk_bf16_f32 v57, v58, v59
    v_exp_f32 v60, v60
    s_mul_i32 s78, s37, 102400
    s_add_u32 s78, s78, 1048576
    s_add_u32 m0, s77, 0
    s_add_u32 s70, m0, s78
    buffer_load_dwordx4 v1, s[32:35], s70 offen sc1 lds
    s_add_u32 m0, s77, 8192
    s_add_u32 s70, m0, s78
    buffer_load_dwordx4 v1, s[32:35], s70 offen sc1 lds
    v_exp_f32 v61, v61
    s_waitcnt lgkmcnt(3)
    v_mfma_f32_32x32x16_bf16 v[8:23], v[72:75], v[48:51], v[8:23]
    ds_read_b128 v[72:75], v70 offset:33536
    v_exp_f32 v62, v62
    v_exp_f32 v63, v63
    v_cvt_pk_bf16_f32 v58, v60, v61
    v_cvt_pk_bf16_f32 v59, v62, v63
    s_setprio 3
    v_exp_f32 v32, v32
    v_exp_f32 v33, v33
    s_waitcnt lgkmcnt(3)
    v_mfma_f32_32x32x16_bf16 v[8:23], v[76:79], v[56:59], v[8:23]
    ds_read_b128 v[76:79], v70 offset:34240
    v_exp_f32 v34, v34
    v_exp_f32 v35, v35
    v_cvt_pk_bf16_f32 v32, v32, v33
    v_cvt_pk_bf16_f32 v33, v34, v35
    v_exp_f32 v36, v36
    s_add_u32 m0, s77, 16384
    s_add_u32 s70, m0, s78
    buffer_load_dwordx4 v1, s[32:35], s70 offen sc1 lds
    v_exp_f32 v37, v37
    s_waitcnt lgkmcnt(3)
    v_mfma_f32_32x32x16_bf16 v[48:63], v[64:67], v[24:27], 0
    ds_read_b128 v[64:67], v30 offset:37632
    v_exp_f32 v38, v38
    v_exp_f32 v39, v39
    s_setprio 2
    v_cvt_pk_bf16_f32 v34, v36, v37
    v_cvt_pk_bf16_f32 v35, v38, v39
    v_exp_f32 v40, v40
    v_exp_f32 v41, v41
    s_waitcnt lgkmcnt(3)
    v_mfma_f32_32x32x8_bf16 v[48:63], v[68:69], v[28:29], v[48:63]
    ds_read_b64 v[68:69], v71 offset:37632
    v_exp_f32 v42, v42
    v_exp_f32 v43, v43
    v_cvt_pk_bf16_f32 v40, v40, v41
    v_cvt_pk_bf16_f32 v41, v42, v43
    v_exp_f32 v44, v44
    s_add_u32 m0, s77, 24576
    s_add_u32 s70, m0, s78
    buffer_load_dwordx4 v1, s[32:35], s70 offen sc1 lds
    v_exp_f32 v45, v45
    s_waitcnt lgkmcnt(3)
    v_mfma_f32_32x32x16_bf16 v[8:23], v[72:75], v[32:35], v[8:23]
    ds_read_b128 v[72:75], v70 offset:36224
    v_exp_f32 v46, v46
    v_exp_f32 v47, v47
    v_cvt_pk_bf16_f32 v42, v44, v45
    v_cvt_pk_bf16_f32 v43, v46, v47
    s_setprio 1
    v_exp_f32 v48, v48
    v_exp_f32 v49, v49
    s_waitcnt lgkmcnt(3)
    v_mfma_f32_32x32x16_bf16 v[8:23], v[76:79], v[40:43], v[8:23]
    ds_read_b128 v[76:79], v70 offset:36928
    v_exp_f32 v50, v50
    v_exp_f32 v51, v51
    v_cvt_pk_bf16_f32 v48, v48, v49
    v_cvt_pk_bf16_f32 v49, v50, v51
    v_exp_f32 v52, v52
    s_add_u32 m0, s77, 32768
    s_add_u32 s70, m0, s78
    buffer_load_dwordx4 v1, s[32:35], s70 offen sc1 lds
    v_exp_f32 v53, v53
    s_waitcnt lgkmcnt(3)
    v_mfma_f32_32x32x16_bf16 v[32:47], v[64:67], v[24:27], 0
    ds_read_b128 v[64:67], v30 offset:40320
    v_exp_f32 v54, v54
    v_exp_f32 v55, v55
    s_setprio 0
    v_cvt_pk_bf16_f32 v50, v52, v53
    v_cvt_pk_bf16_f32 v51, v54, v55
    v_exp_f32 v56, v56
    v_exp_f32 v57, v57
    s_waitcnt lgkmcnt(3)
    v_mfma_f32_32x32x8_bf16 v[32:47], v[68:69], v[28:29], v[32:47]
    ds_read_b64 v[68:69], v71 offset:40320
    v_exp_f32 v58, v58
    v_exp_f32 v59, v59
    v_cvt_pk_bf16_f32 v56, v56, v57
    v_cvt_pk_bf16_f32 v57, v58, v59
    v_exp_f32 v60, v60
    s_add_u32 m0, s77, 40960
    s_add_u32 s70, m0, s78
    buffer_load_dwordx4 v1, s[32:35], s70 offen sc1 lds
    v_exp_f32 v61, v61
    s_waitcnt lgkmcnt(3)
    v_mfma_f32_32x32x16_bf16 v[8:23], v[72:75], v[48:51], v[8:23]
    ds_read_b128 v[72:75], v70 offset:38912
    v_exp_f32 v62, v62
    v_exp_f32 v63, v63
    v_cvt_pk_bf16_f32 v58, v60, v61
    v_cvt_pk_bf16_f32 v59, v62, v63
    s_waitcnt vmcnt(7)
    s_waitcnt vmcnt(8)
    v_readfirstlane_b32 s70, v87
    s_nop 1
    v_cmp_ne_u32 vcc, s70, v87
    s_nop 0
    s_cmp_eq_u64 vcc, 0
    s_cselect_b32 s4, 1, 0
    s_barrier
    s_setprio 3
    v_exp_f32 v32, v32
    v_exp_f32 v33, v33
    s_waitcnt lgkmcnt(3)
    v_mfma_f32_32x32x16_bf16 v[8:23], v[76:79], v[56:59], v[8:23]
    ds_read_b128 v[76:79], v70 offset:39616
    v_exp_f32 v34, v34
    v_exp_f32 v35, v35
    v_cvt_pk_bf16_f32 v32, v32, v33
    v_cvt_pk_bf16_f32 v33, v34, v35
    v_exp_f32 v36, v36
    s_add_u32 m0, s77, 122880
    s_add_u32 s70, s76, 106496
    buffer_load_dwordx4 v1, s[32:35], s70 offen sc1 lds
    v_exp_f32 v37, v37
    s_waitcnt lgkmcnt(3)
    v_mfma_f32_32x32x16_bf16 v[48:63], v[64:67], v[24:27], 0
    ds_read_b128 v[64:67], v30 offset:0
    v_exp_f32 v38, v38
    v_exp_f32 v39, v39
    s_setprio 2
    v_cvt_pk_bf16_f32 v34, v36, v37
    v_cvt_pk_bf16_f32 v35, v38, v39
    v_exp_f32 v40, v40
    v_exp_f32 v41, v41
    s_waitcnt lgkmcnt(3)
    v_mfma_f32_32x32x8_bf16 v[48:63], v[68:69], v[28:29], v[48:63]
    ds_read_b64 v[68:69], v71 offset:0
    v_exp_f32 v42, v42
    v_exp_f32 v43, v43
    v_cvt_pk_bf16_f32 v40, v40, v41
    v_cvt_pk_bf16_f32 v41, v42, v43
    v_exp_f32 v44, v44
    s_add_u32 m0, s77, 49152
    s_add_u32 s70, m0, s78
    buffer_load_dwordx4 v1, s[32:35], s70 offen sc1 lds
    v_exp_f32 v45, v45
    s_waitcnt lgkmcnt(3)
    v_mfma_f32_32x32x16_bf16 v[8:23], v[72:75], v[32:35], v[8:23]
    ds_read_b128 v[72:75], v70 offset:41600
    v_exp_f32 v46, v46
    v_exp_f32 v47, v47
    v_cvt_pk_bf16_f32 v42, v44, v45
    v_cvt_pk_bf16_f32 v43, v46, v47
    s_setprio 1
    v_exp_f32 v48, v48
    v_exp_f32 v49, v49
    s_waitcnt lgkmcnt(3)
    v_mfma_f32_32x32x16_bf16 v[8:23], v[76:79], v[40:43], v[8:23]
    ds_read_b128 v[76:79], v70 offset:42304
    v_exp_f32 v50, v50
    v_exp_f32 v51, v51
    v_cvt_pk_bf16_f32 v48, v48, v49
    v_cvt_pk_bf16_f32 v49, v50, v51
    v_exp_f32 v52, v52
    s_add_u32 m0, s77, 57344
    s_add_u32 s70, m0, s78
    buffer_load_dwordx4 v1, s[32:35], s70 offen sc1 lds
    v_exp_f32 v53, v53
    s_waitcnt lgkmcnt(3)
    v_mfma_f32_32x32x16_bf16 v[32:47], v[64:67], v[24:27], 0
    ds_read_b128 v[64:67], v30 offset:2688
    v_exp_f32 v54, v54
    v_exp_f32 v55, v55
    s_setprio 0
    v_cvt_pk_bf16_f32 v50, v52, v53
    v_cvt_pk_bf16_f32 v51, v54, v55
    v_exp_f32 v56, v56
    v_exp_f32 v57, v57
    s_waitcnt lgkmcnt(3)
    v_mfma_f32_32x32x8_bf16 v[32:47], v[68:69], v[28:29], v[32:47]
    ds_read_b64 v[68:69], v71 offset:2688
    v_exp_f32 v58, v58
    v_exp_f32 v59, v59
    v_cvt_pk_bf16_f32 v56, v56, v57
    v_cvt_pk_bf16_f32 v57, v58, v59
    v_exp_f32 v60, v60
    s_add_u32 m0, s77, 65536
    s_add_u32 s70, m0, s78
    buffer_load_dwordx4 v1, s[32:35], s70 offen sc1 lds
    v_exp_f32 v61, v61
    s_waitcnt lgkmcnt(3)
    v_mfma_f32_32x32x16_bf16 v[8:23], v[72:75], v[48:51], v[8:23]
    ds_read_b128 v[72:75], v70 offset:1280
    v_exp_f32 v62, v62
    v_exp_f32 v63, v63
    v_cvt_pk_bf16_f32 v58, v60, v61
    v_cvt_pk_bf16_f32 v59, v62, v63
    s_setprio 3
    v_exp_f32 v32, v32
    v_exp_f32 v33, v33
    s_waitcnt lgkmcnt(3)
    v_mfma_f32_32x32x16_bf16 v[8:23], v[76:79], v[56:59], v[8:23]
    ds_read_b128 v[76:79], v70 offset:1984
    v_exp_f32 v34, v34
    v_exp_f32 v35, v35
    v_cvt_pk_bf16_f32 v32, v32, v33
    v_cvt_pk_bf16_f32 v33, v34, v35
    v_exp_f32 v36, v36
    s_add_u32 m0, s77, 73728
    s_add_u32 s70, m0, s78
    buffer_load_dwordx4 v1, s[32:35], s70 offen sc1 lds
    v_exp_f32 v37, v37
    s_waitcnt lgkmcnt(3)
    v_mfma_f32_32x32x16_bf16 v[48:63], v[64:67], v[24:27], 0
    ds_read_b128 v[64:67], v30 offset:5376
    v_exp_f32 v38, v38
    v_exp_f32 v39, v39
    s_setprio 2
    v_cvt_pk_bf16_f32 v34, v36, v37
    v_cvt_pk_bf16_f32 v35, v38, v39
    v_exp_f32 v40, v40
    v_exp_f32 v41, v41
    s_waitcnt lgkmcnt(3)
    v_mfma_f32_32x32x8_bf16 v[48:63], v[68:69], v[28:29], v[48:63]
    ds_read_b64 v[68:69], v71 offset:5376
    v_exp_f32 v42, v42
    v_exp_f32 v43, v43
    v_cvt_pk_bf16_f32 v40, v40, v41
    v_cvt_pk_bf16_f32 v41, v42, v43
    v_exp_f32 v44, v44
    s_add_u32 m0, s77, 81920
    s_add_u32 s70, m0, s78
    buffer_load_dwordx4 v1, s[32:35], s70 offen sc1 lds
    v_exp_f32 v45, v45
    s_waitcnt lgkmcnt(3)
    v_mfma_f32_32x32x16_bf16 v[8:23], v[72:75], v[32:35], v[8:23]
    ds_read_b128 v[72:75], v70 offset:3968
    v_exp_f32 v46, v46
    v_exp_f32 v47, v47
    v_cvt_pk_bf16_f32 v42, v44, v45
    v_cvt_pk_bf16_f32 v43, v46, v47
    s_setprio 1
    v_exp_f32 v48, v48
    v_exp_f32 v49, v49
    s_waitcnt lgkmcnt(3)
    v_mfma_f32_32x32x16_bf16 v[8:23], v[76:79], v[40:43], v[8:23]
    ds_read_b128 v[76:79], v70 offset:4672
    v_exp_f32 v50, v50
    v_exp_f32 v51, v51
    v_cvt_pk_bf16_f32 v48, v48, v49
    v_cvt_pk_bf16_f32 v49, v50, v51
    v_exp_f32 v52, v52
    s_add_u32 m0, s77, 90112
    s_add_u32 s70, m0, s78
    buffer_load_dwordx4 v1, s[32:35], s70 offen sc1 lds
    v_exp_f32 v53, v53
    s_waitcnt lgkmcnt(3)
    v_mfma_f32_32x32x16_bf16 v[32:47], v[64:67], v[24:27], 0
    ds_read_b128 v[64:67], v30 offset:8064
    v_exp_f32 v54, v54
    v_exp_f32 v55, v55
    s_setprio 0
    v_cvt_pk_bf16_f32 v50, v52, v53
    v_cvt_pk_bf16_f32 v51, v54, v55
    v_exp_f32 v56, v56
    v_exp_f32 v57, v57
    s_waitcnt lgkmcnt(3)
    v_mfma_f32_32x32x8_bf16 v[32:47], v[68:69], v[28:29], v[32:47]
    ds_read_b64 v[68:69], v71 offset:8064
    v_exp_f32 v58, v58
    v_exp_f32 v59, v59
    v_cvt_pk_bf16_f32 v56, v56, v57
    v_cvt_pk_bf16_f32 v57, v58, v59
    v_exp_f32 v60, v60
    s_min_u32 s70, s77, 3072
    s_add_u32 m0, s70, 98304
    s_add_u32 s70, m0, s78
    buffer_load_dwordx4 v1, s[32:35], s70 offen sc1 lds
    v_exp_f32 v61, v61
    s_waitcnt lgkmcnt(3)
    v_mfma_f32_32x32x16_bf16 v[8:23], v[72:75], v[48:51], v[8:23]
    ds_read_b128 v[72:75], v70 offset:6656
    v_exp_f32 v62, v62
    v_exp_f32 v63, v63
    v_cvt_pk_bf16_f32 v58, v60, v61
    v_cvt_pk_bf16_f32 v59, v62, v63
    s_waitcnt vmcnt(7)
    s_barrier
    s_setprio 3
    v_exp_f32 v32, v32
    v_exp_f32 v33, v33
    s_waitcnt lgkmcnt(3)
    v_mfma_f32_32x32x16_bf16 v[8:23], v[76:79], v[56:59], v[8:23]
    ds_read_b128 v[76:79], v70 offset:7360
    v_exp_f32 v34, v34
    v_exp_f32 v35, v35
    v_cvt_pk_bf16_f32 v32, v32, v33
    v_cvt_pk_bf16_f32 v33, v34, v35
    v_exp_f32 v36, v36
    s_add_u32 m0, s77, 131072
    s_add_u32 s70, s76, 114688
    buffer_load_dwordx4 v1, s[32:35], s70 offen sc1 lds
    v_exp_f32 v37, v37
    s_waitcnt lgkmcnt(3)
    v_mfma_f32_32x32x16_bf16 v[48:63], v[64:67], v[24:27], 0
    ds_read_b128 v[64:67], v30 offset:10752
    v_exp_f32 v38, v38
    v_exp_f32 v39, v39
    s_setprio 2
    v_cvt_pk_bf16_f32 v34, v36, v37
    v_cvt_pk_bf16_f32 v35, v38, v39
    v_exp_f32 v40, v40
    v_exp_f32 v41, v41
    s_waitcnt lgkmcnt(3)
    v_mfma_f32_32x32x8_bf16 v[48:63], v[68:69], v[28:29], v[48:63]
    ds_read_b64 v[68:69], v71 offset:10752
    v_exp_f32 v42, v42
    v_exp_f32 v43, v43
    v_cvt_pk_bf16_f32 v40, v40, v41
    v_cvt_pk_bf16_f32 v41, v42, v43
    v_exp_f32 v44, v44
    s_lshl_b32 s70, s37, 2
    s_add_u32 s70, s70, s45
    s_mul_i32 s70, s70, 60
    s_mul_i32 s71, s44, 10
    s_add_u32 s70, s70, s71
    s_lshl_b32 s70, s70, 10
    s_add_u32 s78, s70, 2097152
    buffer_load_dwordx4 a[0:3], v1, s[32:35], s78 offen offset:0 sc1
    v_exp_f32 v45, v45
    s_waitcnt lgkmcnt(3)
    v_mfma_f32_32x32x16_bf16 v[8:23], v[72:75], v[32:35], v[8:23]
    ds_read_b128 v[72:75], v70 offset:9344
    v_exp_f32 v46, v46
    v_exp_f32 v47, v47
    v_cvt_pk_bf16_f32 v42, v44, v45
    v_cvt_pk_bf16_f32 v43, v46, v47
    s_setprio 1
    v_exp_f32 v48, v48
    v_exp_f32 v49, v49
    s_waitcnt lgkmcnt(3)
    v_mfma_f32_32x32x16_bf16 v[8:23], v[76:79], v[40:43], v[8:23]
    ds_read_b128 v[76:79], v70 offset:10048
    v_exp_f32 v50, v50
    v_exp_f32 v51, v51
    v_cvt_pk_bf16_f32 v48, v48, v49
    v_cvt_pk_bf16_f32 v49, v50, v51
    v_exp_f32 v52, v52
    buffer_load_dwordx4 a[4:7], v1, s[32:35], s78 offen offset:1024 sc1
    v_exp_f32 v53, v53
    s_waitcnt lgkmcnt(3)
    v_mfma_f32_32x32x16_bf16 v[32:47], v[64:67], v[24:27], 0
    ds_read_b128 v[64:67], v30 offset:13440
    v_exp_f32 v54, v54
    v_exp_f32 v55, v55
    s_setprio 0
    v_cvt_pk_bf16_f32 v50, v52, v53
    v_cvt_pk_bf16_f32 v51, v54, v55
    v_exp_f32 v56, v56
    v_exp_f32 v57, v57
    s_waitcnt lgkmcnt(3)
    v_mfma_f32_32x32x8_bf16 v[32:47], v[68:69], v[28:29], v[32:47]
    ds_read_b64 v[68:69], v71 offset:13440
    v_exp_f32 v58, v58
    v_exp_f32 v59, v59
    v_cvt_pk_bf16_f32 v56, v56, v57
    v_cvt_pk_bf16_f32 v57, v58, v59
    v_exp_f32 v60, v60
    buffer_load_dwordx4 a[8:11], v1, s[32:35], s78 offen offset:2048 sc1
    v_exp_f32 v61, v61
    s_waitcnt lgkmcnt(3)
    v_mfma_f32_32x32x16_bf16 v[8:23], v[72:75], v[48:51], v[8:23]
    ds_read_b128 v[72:75], v70 offset:12032
    v_exp_f32 v62, v62
    v_exp_f32 v63, v63
    v_cvt_pk_bf16_f32 v58, v60, v61
    v_cvt_pk_bf16_f32 v59, v62, v63
    s_setprio 3
    v_exp_f32 v32, v32
    v_exp_f32 v33, v33
    s_waitcnt lgkmcnt(3)
    v_mfma_f32_32x32x16_bf16 v[8:23], v[76:79], v[56:59], v[8:23]
    ds_read_b128 v[76:79], v70 offset:12736
    v_exp_f32 v34, v34
    v_exp_f32 v35, v35
    v_cvt_pk_bf16_f32 v32, v32, v33
    v_cvt_pk_bf16_f32 v33, v34, v35
    v_exp_f32 v36, v36
    buffer_load_dwordx4 a[12:15], v1, s[32:35], s78 offen offset:3072 sc1
    v_exp_f32 v37, v37
    s_waitcnt lgkmcnt(3)
    v_mfma_f32_32x32x16_bf16 v[48:63], v[64:67], v[24:27], 0
    ds_read_b128 v[64:67], v30 offset:16128
    v_exp_f32 v38, v38
    v_exp_f32 v39, v39
    s_setprio 2
    v_cvt_pk_bf16_f32 v34, v36, v37
    v_cvt_pk_bf16_f32 v35, v38, v39
    v_exp_f32 v40, v40
    v_exp_f32 v41, v41
    s_waitcnt lgkmcnt(3)
    v_mfma_f32_32x32x8_bf16 v[48:63], v[68:69], v[28:29], v[48:63]
    ds_read_b64 v[68:69], v71 offset:16128
    v_exp_f32 v42, v42
    v_exp_f32 v43, v43
    v_cvt_pk_bf16_f32 v40, v40, v41
    v_cvt_pk_bf16_f32 v41, v42, v43
    v_exp_f32 v44, v44
    s_add_u32 s78, s78, 4096
    buffer_load_dwordx4 a[16:19], v1, s[32:35], s78 offen offset:0 sc1
    v_exp_f32 v45, v45
    s_waitcnt lgkmcnt(3)
    v_mfma_f32_32x32x16_bf16 v[8:23], v[72:75], v[32:35], v[8:23]
    ds_read_b128 v[72:75], v70 offset:14720
    v_exp_f32 v46, v46
    v_exp_f32 v47, v47
    v_cvt_pk_bf16_f32 v42, v44, v45
    v_cvt_pk_bf16_f32 v43, v46, v47
    s_setprio 1
    v_exp_f32 v48, v48
    v_exp_f32 v49, v49
    s_waitcnt lgkmcnt(3)
    v_mfma_f32_32x32x16_bf16 v[8:23], v[76:79], v[40:43], v[8:23]
    ds_read_b128 v[76:79], v70 offset:15424
    v_exp_f32 v50, v50
    v_exp_f32 v51, v51
    v_cvt_pk_bf16_f32 v48, v48, v49
    v_cvt_pk_bf16_f32 v49, v50, v51
    v_exp_f32 v52, v52
    buffer_load_dwordx4 a[20:23], v1, s[32:35], s78 offen offset:1024 sc1
    v_exp_f32 v53, v53
    s_waitcnt lgkmcnt(3)
    v_mfma_f32_32x32x16_bf16 v[32:47], v[64:67], v[24:27], 0
    ds_read_b128 v[64:67], v30 offset:18816
    v_exp_f32 v54, v54
    v_exp_f32 v55, v55
    s_setprio 0
    v_cvt_pk_bf16_f32 v50, v52, v53
    v_cvt_pk_bf16_f32 v51, v54, v55
    v_exp_f32 v56, v56
    v_exp_f32 v57, v57
    s_waitcnt lgkmcnt(3)
    v_mfma_f32_32x32x8_bf16 v[32:47], v[68:69], v[28:29], v[32:47]
    ds_read_b64 v[68:69], v71 offset:18816
    v_exp_f32 v58, v58
    v_exp_f32 v59, v59
    v_cvt_pk_bf16_f32 v56, v56, v57
    v_cvt_pk_bf16_f32 v57, v58, v59
    v_exp_f32 v60, v60
    buffer_load_dwordx4 a[24:27], v1, s[32:35], s78 offen offset:2048 sc1
    v_exp_f32 v61, v61
    s_waitcnt lgkmcnt(3)
    v_mfma_f32_32x32x16_bf16 v[8:23], v[72:75], v[48:51], v[8:23]
    ds_read_b128 v[72:75], v70 offset:17408
    v_exp_f32 v62, v62
    v_exp_f32 v63, v63
    v_cvt_pk_bf16_f32 v58, v60, v61
    v_cvt_pk_bf16_f32 v59, v62, v63
    s_waitcnt vmcnt(7)
    s_barrier
    s_setprio 3
    v_exp_f32 v32, v32
    v_exp_f32 v33, v33
    s_waitcnt lgkmcnt(3)
    v_mfma_f32_32x32x16_bf16 v[8:23], v[76:79], v[56:59], v[8:23]
    ds_read_b128 v[76:79], v70 offset:18112
    v_exp_f32 v34, v34
    v_exp_f32 v35, v35
    v_cvt_pk_bf16_f32 v32, v32, v33
    v_cvt_pk_bf16_f32 v33, v34, v35
    v_exp_f32 v36, v36
    s_cmp_ge_u32 s38, 6
    s_cselect_b32 s70, 43008, 0
    s_sub_u32 s70, s77, s70
    s_add_u32 m0, s70, 139264
    s_add_u32 s70, s76, 122880
    buffer_load_dwordx4 v1, s[32:35], s70 offen sc1 lds
    v_exp_f32 v37, v37
    s_waitcnt lgkmcnt(3)
    v_mfma_f32_32x32x16_bf16 v[48:63], v[64:67], v[24:27], 0
    ds_read_b128 v[64:67], v30 offset:21504
    v_exp_f32 v38, v38
    v_exp_f32 v39, v39
    s_setprio 2
    v_cvt_pk_bf16_f32 v34, v36, v37
    v_cvt_pk_bf16_f32 v35, v38, v39
    v_exp_f32 v40, v40
    v_exp_f32 v41, v41
    s_waitcnt lgkmcnt(3)
    v_mfma_f32_32x32x8_bf16 v[48:63], v[68:69], v[28:29], v[48:63]
    ds_read_b64 v[68:69], v71 offset:21504
    v_exp_f32 v42, v42
    v_exp_f32 v43, v43
    v_cvt_pk_bf16_f32 v40, v40, v41
    v_cvt_pk_bf16_f32 v41, v42, v43
    v_exp_f32 v44, v44
    s_add_u32 m0, s77, 104448
    s_add_u32 s70, s76, 131072
    buffer_load_dwordx4 v1, s[32:35], s70 offen sc1 lds
    buffer_load_dwordx4 a[28:31], v1, s[32:35], s78 offen offset:3072 sc1
    v_exp_f32 v45, v45
    s_waitcnt lgkmcnt(3)
    v_mfma_f32_32x32x16_bf16 v[8:23], v[72:75], v[32:35], v[8:23]
    ds_read_b128 v[72:75], v70 offset:20096
    v_exp_f32 v46, v46
    v_exp_f32 v47, v47
    v_cvt_pk_bf16_f32 v42, v44, v45
    v_cvt_pk_bf16_f32 v43, v46, v47
    s_setprio 1
    v_exp_f32 v48, v48
    v_exp_f32 v49, v49
    s_waitcnt lgkmcnt(3)
    v_mfma_f32_32x32x16_bf16 v[8:23], v[76:79], v[40:43], v[8:23]
    ds_read_b128 v[76:79], v70 offset:20800
    v_exp_f32 v50, v50
    v_exp_f32 v51, v51
    v_cvt_pk_bf16_f32 v48, v48, v49
    v_cvt_pk_bf16_f32 v49, v50, v51
    v_exp_f32 v52, v52
    s_add_u32 s78, s78, 4096
    buffer_load_dwordx4 a[32:35], v1, s[32:35], s78 offen offset:0 sc1
    v_exp_f32 v53, v53
    s_waitcnt lgkmcnt(3)
    v_mfma_f32_32x32x16_bf16 v[32:47], v[64:67], v[24:27], 0
    ds_read_b128 v[64:67], v30 offset:24192
    v_exp_f32 v54, v54
    v_exp_f32 v55, v55
    s_setprio 0
    v_cvt_pk_bf16_f32 v50, v52, v53
    v_cvt_pk_bf16_f32 v51, v54, v55
    v_exp_f32 v56, v56
    v_exp_f32 v57, v57
    s_waitcnt lgkmcnt(3)
    v_mfma_f32_32x32x8_bf16 v[32:47], v[68:69], v[28:29], v[32:47]
    ds_read_b64 v[68:69], v71 offset:24192
    v_exp_f32 v58, v58
    v_exp_f32 v59, v59
    v_cvt_pk_bf16_f32 v56, v56, v57
    v_cvt_pk_bf16_f32 v57, v58, v59
    v_exp_f32 v60, v60
    buffer_load_dwordx4 a[36:39], v1, s[32:35], s78 offen offset:1024 sc1
    v_exp_f32 v61, v61
    s_waitcnt lgkmcnt(3)
    v_mfma_f32_32x32x16_bf16 v[8:23], v[72:75], v[48:51], v[8:23]
    ds_read_b128 v[72:75], v70 offset:22784
    v_exp_f32 v62, v62
    v_exp_f32 v63, v63
    v_cvt_pk_bf16_f32 v58, v60, v61
    v_cvt_pk_bf16_f32 v59, v62, v63
    s_setprio 3
    v_exp_f32 v32, v32
    v_exp_f32 v33, v33
    s_waitcnt lgkmcnt(3)
    v_mfma_f32_32x32x16_bf16 v[8:23], v[76:79], v[56:59], v[8:23]
    ds_read_b128 v[76:79], v70 offset:23488
    v_exp_f32 v34, v34
    v_exp_f32 v35, v35
    v_cvt_pk_bf16_f32 v32, v32, v33
    v_cvt_pk_bf16_f32 v33, v34, v35
    v_exp_f32 v36, v36
    s_add_u32 s78, s78, 12288
    buffer_load_dwordx4 a[40:43], v1, s[32:35], s78 offen offset:0 sc1
    v_exp_f32 v37, v37
    s_waitcnt lgkmcnt(3)
    v_mfma_f32_32x32x16_bf16 v[48:63], v[64:67], v[24:27], 0
    ds_read_b128 v[64:67], v30 offset:26880
    v_exp_f32 v38, v38
    v_exp_f32 v39, v39
    s_setprio 2
    v_cvt_pk_bf16_f32 v34, v36, v37
    v_cvt_pk_bf16_f32 v35, v38, v39
    v_exp_f32 v40, v40
    v_exp_f32 v41, v41
    s_waitcnt lgkmcnt(3)
    v_mfma_f32_32x32x8_bf16 v[48:63], v[68:69], v[28:29], v[48:63]
    ds_read_b64 v[68:69], v71 offset:26880
    v_exp_f32 v42, v42
    v_exp_f32 v43, v43
    v_cvt_pk_bf16_f32 v40, v40, v41
    v_cvt_pk_bf16_f32 v41, v42, v43
    v_exp_f32 v44, v44
    buffer_load_dwordx4 a[44:47], v1, s[32:35], s78 offen offset:1024 sc1
    v_exp_f32 v45, v45
    s_waitcnt lgkmcnt(3)
    v_mfma_f32_32x32x16_bf16 v[8:23], v[72:75], v[32:35], v[8:23]
    ds_read_b128 v[72:75], v70 offset:25472
    v_exp_f32 v46, v46
    v_exp_f32 v47, v47
    v_cvt_pk_bf16_f32 v42, v44, v45
    v_cvt_pk_bf16_f32 v43, v46, v47
    s_setprio 1
    v_exp_f32 v48, v48
    v_exp_f32 v49, v49
    s_waitcnt lgkmcnt(3)
    v_mfma_f32_32x32x16_bf16 v[8:23], v[76:79], v[40:43], v[8:23]
    ds_read_b128 v[76:79], v70 offset:26176
    v_exp_f32 v50, v50
    v_exp_f32 v51, v51
    v_cvt_pk_bf16_f32 v48, v48, v49
    v_cvt_pk_bf16_f32 v49, v50, v51
    v_exp_f32 v52, v52
    s_cmp_lg_u32 s38, 7
    s_cbranch_scc1 L_pc_20_e
    s_getpc_b64 s[72:73]
L_pc_20:
    s_and_b32 s70, s72, 4095
    s_sub_u32 s70, 4096, s70
    v_lshrrev_b32 v124, 3, v0
    v_lshlrev_b32 v124, 12, v124
    v_and_b32 v125, 7, v0
    v_lshl_add_u32 v124, v125, 7, v124
    v_add_u32 v124, s70, v124
    v_min_u32 v124, L_slow-L_pc_20, v124
    v_mov_b32 v125, s73
    v_add_co_u32 v124, vcc, s72, v124
    s_nop 1
    v_addc_co_u32 v125, vcc, 0, v125, vcc
    global_load_dword a127, v[124:125], off
L_pc_20_e:
    v_exp_f32 v53, v53
    s_waitcnt lgkmcnt(3)
    v_mfma_f32_32x32x16_bf16 v[32:47], v[64:67], v[24:27], 0
    ds_read_b128 v[64:67], v30 offset:29568
    v_exp_f32 v54, v54
    v_exp_f32 v55, v55
    s_setprio 0
    v_cvt_pk_bf16_f32 v50, v52, v53
    v_cvt_pk_bf16_f32 v51, v54, v55
    v_exp_f32 v56, v56
    v_exp_f32 v57, v57
    s_waitcnt lgkmcnt(3)
    v_mfma_f32_32x32x8_bf16 v[32:47], v[68:69], v[28:29], v[32:47]
    ds_read_b64 v[68:69], v71 offset:29568
    v_exp_f32 v58, v58
    v_exp_f32 v59, v59
    v_cvt_pk_bf16_f32 v56, v56, v57
    v_cvt_pk_bf16_f32 v57, v58, v59
    v_exp_f32 v60, v60
    buffer_load_dwordx4 a[48:51], v1, s[32:35], s78 offen offset:2048 sc1
    v_exp_f32 v61, v61
    s_waitcnt lgkmcnt(3)
    v_mfma_f32_32x32x16_bf16 v[8:23], v[72:75], v[48:51], v[8:23]
    ds_read_b128 v[72:75], v70 offset:28160
    v_exp_f32 v62, v62
    v_exp_f32 v63, v63
    v_cvt_pk_bf16_f32 v58, v60, v61
    v_cvt_pk_bf16_f32 v59, v62, v63
    s_waitcnt vmcnt(7)
    s_barrier
    s_setprio 3
    v_exp_f32 v32, v32
    v_exp_f32 v33, v33
    s_waitcnt lgkmcnt(3)
    v_mfma_f32_32x32x16_bf16 v[8:23], v[76:79], v[56:59], v[8:23]
    ds_read_b128 v[76:79], v70 offset:28864
    v_exp_f32 v34, v34
    v_exp_f32 v35, v35
    v_cvt_pk_bf16_f32 v32, v32, v33
    v_cvt_pk_bf16_f32 v33, v34, v35
    v_exp_f32 v36, v36
    s_add_u32 m0, s77, 112640
    s_add_u32 s70, s76, 139264
    buffer_load_dwordx4 v1, s[32:35], s70 offen sc1 lds
    v_exp_f32 v37, v37
    s_waitcnt lgkmcnt(3)
    v_mfma_f32_32x32x16_bf16 v[48:63], v[64:67], v[24:27], 0
    ds_read_b128 v[64:67], v30 offset:32256
    v_exp_f32 v38, v38
    v_exp_f32 v39, v39
    s_setprio 2
    v_cvt_pk_bf16_f32 v34, v36, v37
    v_cvt_pk_bf16_f32 v35, v38, v39
    v_exp_f32 v40, v40
    v_exp_f32 v41, v41
    s_waitcnt lgkmcnt(3)
    v_mfma_f32_32x32x8_bf16 v[48:63], v[68:69], v[28:29], v[48:63]
    ds_read_b64 v[68:69], v71 offset:32256
    v_exp_f32 v42, v42
    v_exp_f32 v43, v43
    v_cvt_pk_bf16_f32 v40, v40, v41
    v_cvt_pk_bf16_f32 v41, v42, v43
    v_exp_f32 v44, v44
    buffer_load_dwordx4 a[52:55], v1, s[32:35], s78 offen offset:3072 sc1
    s_add_u32 s78, s78, 4096
    buffer_load_dwordx4 a[56:59], v1, s[32:35], s78 offen offset:0 sc1
    v_exp_f32 v45, v45
    s_waitcnt lgkmcnt(3)
    v_mfma_f32_32x32x16_bf16 v[8:23], v[72:75], v[32:35], v[8:23]
    ds_read_b128 v[72:75], v70 offset:30848
    v_exp_f32 v46, v46
    v_exp_f32 v47, v47
    v_cvt_pk_bf16_f32 v42, v44, v45
    v_cvt_pk_bf16_f32 v43, v46, v47
    s_setprio 1
    v_exp_f32 v48, v48
    v_exp_f32 v49, v49
    s_waitcnt lgkmcnt(3)
    v_mfma_f32_32x32x16_bf16 v[8:23], v[76:79], v[40:43], v[8:23]
    ds_read_b128 v[76:79], v70 offset:31552
    v_exp_f32 v50, v50
    v_exp_f32 v51, v51
    v_cvt_pk_bf16_f32 v48, v48, v49
    v_cvt_pk_bf16_f32 v49, v50, v51
    v_exp_f32 v52, v52
    buffer_load_dwordx4 a[60:63], v1, s[32:35], s78 offen offset:1024 sc1
    v_exp_f32 v53, v53
    s_waitcnt lgkmcnt(3)
    v_mfma_f32_32x32x16_bf16 v[32:47], v[64:67], v[24:27], 0
    ds_read_b128 v[64:67], v30 offset:34944
    v_exp_f32 v54, v54
    v_exp_f32 v55, v55
    s_setprio 0
    v_cvt_pk_bf16_f32 v50, v52, v53
    v_cvt_pk_bf16_f32 v51, v54, v55
    v_exp_f32 v56, v56
    v_exp_f32 v57, v57
    s_waitcnt lgkmcnt(3)
    v_mfma_f32_32x32x8_bf16 v[32:47], v[68:69], v[28:29], v[32:47]
    ds_read_b64 v[68:69], v71 offset:34944
    v_exp_f32 v58, v58
    v_exp_f32 v59, v59
    v_cvt_pk_bf16_f32 v56, v56, v57
    v_cvt_pk_bf16_f32 v57, v58, v59
    v_exp_f32 v60, v60
    buffer_load_dwordx4 a[64:67], v1, s[32:35], s78 offen offset:2048 sc1
    v_exp_f32 v61, v61
    s_waitcnt lgkmcnt(3)
    v_mfma_f32_32x32x16_bf16 v[8:23], v[72:75], v[48:51], v[8:23]
    ds_read_b128 v[72:75], v70 offset:33536
    v_exp_f32 v62, v62
    v_exp_f32 v63, v63
    v_cvt_pk_bf16_f32 v58, v60, v61
    v_cvt_pk_bf16_f32 v59, v62, v63
    s_setprio 3
    v_exp_f32 v32, v32
    v_exp_f32 v33, v33
    s_waitcnt lgkmcnt(3)
    v_mfma_f32_32x32x16_bf16 v[8:23], v[76:79], v[56:59], v[8:23]
    ds_read_b128 v[76:79], v70 offset:34240
    v_exp_f32 v34, v34
    v_exp_f32 v35, v35
    v_cvt_pk_bf16_f32 v32, v32, v33
    v_cvt_pk_bf16_f32 v33, v34, v35
    v_exp_f32 v36, v36
    buffer_load_dwordx4 a[68:71], v1, s[32:35], s78 offen offset:3072 sc1
    v_exp_f32 v37, v37
    s_waitcnt lgkmcnt(3)
    v_mfma_f32_32x32x16_bf16 v[48:63], v[64:67], v[24:27], 0
    ds_read_b128 v[64:67], v30 offset:37632
    v_exp_f32 v38, v38
    v_exp_f32 v39, v39
    s_setprio 2
    v_cvt_pk_bf16_f32 v34, v36, v37
    v_cvt_pk_bf16_f32 v35, v38, v39
    v_exp_f32 v40, v40
    v_exp_f32 v41, v41
    s_waitcnt lgkmcnt(3)
    v_mfma_f32_32x32x8_bf16 v[48:63], v[68:69], v[28:29], v[48:63]
    ds_read_b64 v[68:69], v71 offset:37632
    v_exp_f32 v42, v42
    v_exp_f32 v43, v43
    v_cvt_pk_bf16_f32 v40, v40, v41
    v_cvt_pk_bf16_f32 v41, v42, v43
    v_exp_f32 v44, v44
    s_add_u32 s78, s78, 4096
    buffer_load_dwordx4 a[72:75], v1, s[32:35], s78 offen offset:0 sc1
    v_exp_f32 v45, v45
    s_waitcnt lgkmcnt(3)
    v_mfma_f32_32x32x16_bf16 v[8:23], v[72:75], v[32:35], v[8:23]
    ds_read_b128 v[72:75], v70 offset:36224
    v_exp_f32 v46, v46
    v_exp_f32 v47, v47
    v_cvt_pk_bf16_f32 v42, v44, v45
    v_cvt_pk_bf16_f32 v43, v46, v47
    s_setprio 1
    v_exp_f32 v48, v48
    v_exp_f32 v49, v49
    s_waitcnt lgkmcnt(3)
    v_mfma_f32_32x32x16_bf16 v[8:23], v[76:79], v[40:43], v[8:23]
    ds_read_b128 v[76:79], v70 offset:36928
    v_exp_f32 v50, v50
    v_exp_f32 v51, v51
    v_cvt_pk_bf16_f32 v48, v48, v49
    v_cvt_pk_bf16_f32 v49, v50, v51
    v_exp_f32 v52, v52
    buffer_load_dwordx4 a[76:79], v1, s[32:35], s78 offen offset:1024 sc1
    v_exp_f32 v53, v53
    s_waitcnt lgkmcnt(3)
    v_mfma_f32_32x32x16_bf16 v[32:47], v[64:67], v[24:27], 0
    ds_read_b128 v[64:67], v30 offset:40320
    v_exp_f32 v54, v54
    v_exp_f32 v55, v55
    s_setprio 0
    v_cvt_pk_bf16_f32 v50, v52, v53
    v_cvt_pk_bf16_f32 v51, v54, v55
    v_exp_f32 v56, v56
    v_exp_f32 v57, v57
    s_waitcnt lgkmcnt(3)
    v_mfma_f32_32x32x8_bf16 v[32:47], v[68:69], v[28:29], v[32:47]
    ds_read_b64 v[68:69], v71 offset:40320
    v_exp_f32 v58, v58
    v_exp_f32 v59, v59
    v_cvt_pk_bf16_f32 v56, v56, v57
    v_cvt_pk_bf16_f32 v57, v58, v59
    v_exp_f32 v60, v60
    s_add_u32 s78, s78, 12288
    buffer_load_dwordx4 a[80:83], v1, s[32:35], s78 offen offset:0 sc1
    v_exp_f32 v61, v61
    s_waitcnt lgkmcnt(3)
    v_mfma_f32_32x32x16_bf16 v[8:23], v[72:75], v[48:51], v[8:23]
    ds_read_b128 v[72:75], v70 offset:38912
    v_exp_f32 v62, v62
    v_exp_f32 v63, v63
    v_cvt_pk_bf16_f32 v58, v60, v61
    v_cvt_pk_bf16_f32 v59, v62, v63
    s_waitcnt vmcnt(8)
    s_barrier
    s_setprio 3
    v_exp_f32 v32, v32
    v_exp_f32 v33, v33
    s_waitcnt lgkmcnt(3)
    v_mfma_f32_32x32x16_bf16 v[8:23], v[76:79], v[56:59], v[8:23]
    ds_read_b128 v[76:79], v70 offset:39616
    v_exp_f32 v34, v34
    v_exp_f32 v35, v35
    v_cvt_pk_bf16_f32 v32, v32, v33
    v_cvt_pk_bf16_f32 v33, v34, v35
    v_exp_f32 v36, v36
    s_add_u32 m0, s77, 120832
    s_add_u32 s70, s76, 147456
    buffer_load_dwordx4 v1, s[32:35], s70 offen sc1 lds
    v_exp_f32 v37, v37
    s_waitcnt lgkmcnt(3)
    v_mfma_f32_32x32x16_bf16 v[48:63], v[64:67], v[24:27], 0
    ds_read_b128 v[64:67], v30 offset:0
    v_exp_f32 v38, v38
    v_exp_f32 v39, v39
    s_setprio 2
    v_cvt_pk_bf16_f32 v34, v36, v37
    v_cvt_pk_bf16_f32 v35, v38, v39
    v_exp_f32 v40, v40
    v_exp_f32 v41, v41
    s_waitcnt lgkmcnt(3)
    v_mfma_f32_32x32x8_bf16 v[48:63], v[68:69], v[28:29], v[48:63]
    ds_read_b64 v[68:69], v71 offset:0
    v_exp_f32 v42, v42
    v_exp_f32 v43, v43
    v_cvt_pk_bf16_f32 v40, v40, v41
    v_cvt_pk_bf16_f32 v41, v42, v43
    v_exp_f32 v44, v44
    buffer_load_dwordx4 a[84:87], v1, s[32:35], s78 offen offset:1024 sc1
    v_exp_f32 v45, v45
    s_waitcnt lgkmcnt(3)
    v_mfma_f32_32x32x16_bf16 v[8:23], v[72:75], v[32:35], v[8:23]
    ds_read_b128 v[72:75], v70 offset:41600
    v_exp_f32 v46, v46
    v_exp_f32 v47, v47
    v_cvt_pk_bf16_f32 v42, v44, v45
    v_cvt_pk_bf16_f32 v43, v46, v47
    s_setprio 1
    v_exp_f32 v48, v48
    v_exp_f32 v49, v49
    s_waitcnt lgkmcnt(3)
    v_mfma_f32_32x32x16_bf16 v[8:23], v[76:79], v[40:43], v[8:23]
    ds_read_b128 v[76:79], v70 offset:42304
    v_exp_f32 v50, v50
    v_exp_f32 v51, v51
    v_cvt_pk_bf16_f32 v48, v48, v49
    v_cvt_pk_bf16_f32 v49, v50, v51
    v_exp_f32 v52, v52
    buffer_load_dwordx4 a[88:91], v1, s[32:35], s78 offen offset:2048 sc1
    v_exp_f32 v53, v53
    s_waitcnt lgkmcnt(3)
    v_mfma_f32_32x32x16_bf16 v[32:47], v[64:67], v[24:27], 0
    ds_read_b128 v[64:67], v30 offset:2688
    v_exp_f32 v54, v54
    v_exp_f32 v55, v55
    s_setprio 0
    v_cvt_pk_bf16_f32 v50, v52, v53
    v_cvt_pk_bf16_f32 v51, v54, v55
    v_exp_f32 v56, v56
    v_exp_f32 v57, v57
    s_waitcnt lgkmcnt(3)
    v_mfma_f32_32x32x8_bf16 v[32:47], v[68:69], v[28:29], v[32:47]
    ds_read_b64 v[68:69], v71 offset:2688
    v_exp_f32 v58, v58
    v_exp_f32 v59, v59
    v_cvt_pk_bf16_f32 v56, v56, v57
    v_cvt_pk_bf16_f32 v57, v58, v59
    v_exp_f32 v60, v60
    buffer_load_dwordx4 a[92:95], v1, s[32:35], s78 offen offset:3072 sc1
    v_exp_f32 v61, v61
    s_waitcnt lgkmcnt(3)
    v_mfma_f32_32x32x16_bf16 v[8:23], v[72:75], v[48:51], v[8:23]
    ds_read_b128 v[72:75], v70 offset:1280
    v_exp_f32 v62, v62
    v_exp_f32 v63, v63
    v_cvt_pk_bf16_f32 v58, v60, v61
    v_cvt_pk_bf16_f32 v59, v62, v63
    s_setprio 3
    v_exp_f32 v32, v32
    v_exp_f32 v33, v33
    s_waitcnt lgkmcnt(3)
    v_mfma_f32_32x32x16_bf16 v[8:23], v[76:79], v[56:59], v[8:23]
    ds_read_b128 v[76:79], v70 offset:1984
    v_exp_f32 v34, v34
    v_exp_f32 v35, v35
    v_cvt_pk_bf16_f32 v32, v32, v33
    v_cvt_pk_bf16_f32 v33, v34, v35
    v_exp_f32 v36, v36
    s_add_u32 s78, s78, 4096
    buffer_load_dwordx4 a[96:99], v1, s[32:35], s78 offen offset:0 sc1
    v_exp_f32 v37, v37
    s_waitcnt lgkmcnt(3)
    v_mfma_f32_32x32x16_bf16 v[48:63], v[64:67], v[24:27], 0
    ds_read_b128 v[64:67], v30 offset:5376
    v_exp_f32 v38, v38
    v_exp_f32 v39, v39
    s_setprio 2
    v_cvt_pk_bf16_f32 v34, v36, v37
    v_cvt_pk_bf16_f32 v35, v38, v39
    v_exp_f32 v40, v40
    v_exp_f32 v41, v41
    s_waitcnt lgkmcnt(3)
    v_mfma_f32_32x32x8_bf16 v[48:63], v[68:69], v[28:29], v[48:63]
    ds_read_b64 v[68:69], v71 offset:5376
    v_exp_f32 v42, v42
    v_exp_f32 v43, v43
    v_cvt_pk_bf16_f32 v40, v40, v41
    v_cvt_pk_bf16_f32 v41, v42, v43
    v_exp_f32 v44, v44
    buffer_load_dwordx4 a[100:103], v1, s[32:35], s78 offen offset:1024 sc1
    v_exp_f32 v45, v45
    s_waitcnt lgkmcnt(3)
    v_mfma_f32_32x32x16_bf16 v[8:23], v[72:75], v[32:35], v[8:23]
    ds_read_b128 v[72:75], v70 offset:3968
    v_exp_f32 v46, v46
    v_exp_f32 v47, v47
    v_cvt_pk_bf16_f32 v42, v44, v45
    v_cvt_pk_bf16_f32 v43, v46, v47
    s_setprio 1
    v_exp_f32 v48, v48
    v_exp_f32 v49, v49
    s_waitcnt lgkmcnt(3)
    v_mfma_f32_32x32x16_bf16 v[8:23], v[76:79], v[40:43], v[8:23]
    ds_read_b128 v[76:79], v70 offset:4672
    v_exp_f32 v50, v50
    v_exp_f32 v51, v51
    v_cvt_pk_bf16_f32 v48, v48, v49
    v_cvt_pk_bf16_f32 v49, v50, v51
    v_exp_f32 v52, v52
    buffer_load_dwordx4 a[104:107], v1, s[32:35], s78 offen offset:2048 sc1
    v_exp_f32 v53, v53
    s_waitcnt lgkmcnt(3)
    v_mfma_f32_32x32x16_bf16 v[32:47], v[64:67], v[24:27], 0
    ds_read_b128 v[64:67], v30 offset:8064
    v_exp_f32 v54, v54
    v_exp_f32 v55, v55
    s_setprio 0
    v_cvt_pk_bf16_f32 v50, v52, v53
    v_cvt_pk_bf16_f32 v51, v54, v55
    v_exp_f32 v56, v56
    v_exp_f32 v57, v57
    s_waitcnt lgkmcnt(3)
    v_mfma_f32_32x32x8_bf16 v[32:47], v[68:69], v[28:29], v[32:47]
    ds_read_b64 v[68:69], v71 offset:8064
    v_exp_f32 v58, v58
    v_exp_f32 v59, v59
    v_cvt_pk_bf16_f32 v56, v56, v57
    v_cvt_pk_bf16_f32 v57, v58, v59
    v_exp_f32 v60, v60
    buffer_load_dwordx4 a[108:111], v1, s[32:35], s78 offen offset:3072 sc1
    v_exp_f32 v61, v61
    s_waitcnt lgkmcnt(3)
    v_mfma_f32_32x32x16_bf16 v[8:23], v[72:75], v[48:51], v[8:23]
    ds_read_b128 v[72:75], v70 offset:6656
    v_exp_f32 v62, v62
    v_exp_f32 v63, v63
    v_cvt_pk_bf16_f32 v58, v60, v61
    v_cvt_pk_bf16_f32 v59, v62, v63
    s_waitcnt vmcnt(7)
    s_barrier
    s_setprio 3
    v_exp_f32 v32, v32
    v_exp_f32 v33, v33
    s_waitcnt lgkmcnt(3)
    v_mfma_f32_32x32x16_bf16 v[8:23], v[76:79], v[56:59], v[8:23]
    ds_read_b128 v[76:79], v70 offset:7360
    v_exp_f32 v34, v34
    v_exp_f32 v35, v35
    v_cvt_pk_bf16_f32 v32, v32, v33
    v_cvt_pk_bf16_f32 v33, v34, v35
    v_exp_f32 v36, v36
    s_add_u32 m0, s77, 129024
    s_add_u32 s70, s76, 155648
    buffer_load_dwordx4 v1, s[32:35], s70 offen sc1 lds
    v_exp_f32 v37, v37
    s_waitcnt lgkmcnt(3)
    v_mfma_f32_32x32x16_bf16 v[48:63], v[64:67], v[24:27], 0
    ds_read_b128 v[64:67], v30 offset:10752
    v_exp_f32 v38, v38
    v_exp_f32 v39, v39
    s_setprio 2
    v_cvt_pk_bf16_f32 v34, v36, v37
    v_cvt_pk_bf16_f32 v35, v38, v39
    v_exp_f32 v40, v40
    v_exp_f32 v41, v41
    s_waitcnt lgkmcnt(3)
    v_mfma_f32_32x32x8_bf16 v[48:63], v[68:69], v[28:29], v[48:63]
    ds_read_b64 v[68:69], v71 offset:10752
    v_exp_f32 v42, v42
    v_exp_f32 v43, v43
    v_cvt_pk_bf16_f32 v40, v40, v41
    v_cvt_pk_bf16_f32 v41, v42, v43
    v_exp_f32 v44, v44
    s_add_u32 m0, s77, 137216
    s_add_u32 s70, s76, 163840
    buffer_load_dwordx4 v1, s[32:35], s70 offen sc1 lds
    s_add_u32 s78, s78, 4096
    buffer_load_dwordx4 a[112:115], v1, s[32:35], s78 offen offset:0 sc1
    v_exp_f32 v45, v45
    s_waitcnt lgkmcnt(3)
    v_mfma_f32_32x32x16_bf16 v[8:23], v[72:75], v[32:35], v[8:23]
    ds_read_b128 v[72:75], v70 offset:9344
    v_exp_f32 v46, v46
    v_exp_f32 v47, v47
    v_cvt_pk_bf16_f32 v42, v44, v45
    v_cvt_pk_bf16_f32 v43, v46, v47
    s_setprio 1
    v_exp_f32 v48, v48
    v_exp_f32 v49, v49
    s_waitcnt lgkmcnt(3)
    v_mfma_f32_32x32x16_bf16 v[8:23], v[76:79], v[40:43], v[8:23]
    ds_read_b128 v[76:79], v70 offset:10048
    v_exp_f32 v50, v50
    v_exp_f32 v51, v51
    v_cvt_pk_bf16_f32 v48, v48, v49
    v_cvt_pk_bf16_f32 v49, v50, v51
    v_exp_f32 v52, v52
    buffer_load_dwordx4 a[116:119], v1, s[32:35], s78 offen offset:1024 sc1
    v_exp_f32 v53, v53
    s_waitcnt lgkmcnt(3)
    v_mfma_f32_32x32x16_bf16 v[32:47], v[64:67], v[24:27], 0
    ds_read_b128 v[64:67], v30 offset:13440
    v_exp_f32 v54, v54
    v_exp_f32 v55, v55
    s_setprio 0
    v_cvt_pk_bf16_f32 v50, v52, v53
    v_cvt_pk_bf16_f32 v51, v54, v55
    v_exp_f32 v56, v56
    v_exp_f32 v57, v57
    s_waitcnt lgkmcnt(3)
    v_mfma_f32_32x32x8_bf16 v[32:47], v[68:69], v[28:29], v[32:47]
    ds_read_b64 v[68:69], v71 offset:13440
    v_exp_f32 v58, v58
    v_exp_f32 v59, v59
    v_cvt_pk_bf16_f32 v56, v56, v57
    v_cvt_pk_bf16_f32 v57, v58, v59
    v_exp_f32 v60, v60
    s_add_u32 s70, s7, 0
    buffer_load_dwordx4 v[80:83], v1, s[32:35], s70 offen offset:0 sc1
    v_exp_f32 v61, v61
    s_waitcnt lgkmcnt(3)
    v_mfma_f32_32x32x16_bf16 v[8:23], v[72:75], v[48:51], v[8:23]
    ds_read_b128 v[72:75], v70 offset:12032
    v_exp_f32 v62, v62
    v_exp_f32 v63, v63
    v_cvt_pk_bf16_f32 v58, v60, v61
    v_cvt_pk_bf16_f32 v59, v62, v63
    s_setprio 3
    v_exp_f32 v32, v32
    v_exp_f32 v33, v33
    s_waitcnt lgkmcnt(3)
    v_mfma_f32_32x32x16_bf16 v[8:23], v[76:79], v[56:59], v[8:23]
    ds_read_b128 v[76:79], v70 offset:12736
    v_exp_f32 v34, v34
    v_exp_f32 v35, v35
    v_cvt_pk_bf16_f32 v32, v32, v33
    v_cvt_pk_bf16_f32 v33, v34, v35
    v_exp_f32 v36, v36
    s_add_u32 s70, s7, 49152
    buffer_load_dwordx4 v[84:87], v1, s[32:35], s70 offen offset:0 sc1
    v_exp_f32 v37, v37
    s_waitcnt lgkmcnt(3)
    v_mfma_f32_32x32x16_bf16 v[48:63], v[64:67], v[24:27], 0
    ds_read_b128 v[64:67], v30 offset:16128
    v_exp_f32 v38, v38
    v_exp_f32 v39, v39
    s_setprio 2
    v_cvt_pk_bf16_f32 v34, v36, v37
    v_cvt_pk_bf16_f32 v35, v38, v39
    v_exp_f32 v40, v40
    v_exp_f32 v41, v41
    s_waitcnt lgkmcnt(3)
    v_mfma_f32_32x32x8_bf16 v[48:63], v[68:69], v[28:29], v[48:63]
    ds_read_b64 v[68:69], v71 offset:16128
    v_exp_f32 v42, v42
    v_exp_f32 v43, v43
    v_cvt_pk_bf16_f32 v40, v40, v41
    v_cvt_pk_bf16_f32 v41, v42, v43
    v_exp_f32 v44, v44
    s_add_u32 s70, s7, 98304
    buffer_load_dwordx4 v[88:91], v1, s[32:35], s70 offen offset:0 sc1
    v_exp_f32 v45, v45
    s_waitcnt lgkmcnt(3)
    v_mfma_f32_32x32x16_bf16 v[8:23], v[72:75], v[32:35], v[8:23]
    ds_read_b128 v[72:75], v70 offset:14720
    v_exp_f32 v46, v46
    v_exp_f32 v47, v47
    v_cvt_pk_bf16_f32 v42, v44, v45
    v_cvt_pk_bf16_f32 v43, v46, v47
    s_setprio 1
    v_exp_f32 v48, v48
    v_exp_f32 v49, v49
    s_waitcnt lgkmcnt(3)
    v_mfma_f32_32x32x16_bf16 v[8:23], v[76:79], v[40:43], v[8:23]
    ds_read_b128 v[76:79], v70 offset:15424
    v_exp_f32 v50, v50
    v_exp_f32 v51, v51
    v_cvt_pk_bf16_f32 v48, v48, v49
    v_cvt_pk_bf16_f32 v49, v50, v51
    v_exp_f32 v52, v52
    s_add_u32 s70, s7, 147456
    buffer_load_dwordx4 v[92:95], v1, s[32:35], s70 offen offset:0 sc1
    v_exp_f32 v53, v53
    s_waitcnt lgkmcnt(3)
    v_mfma_f32_32x32x16_bf16 v[32:47], v[64:67], v[24:27], 0
    ds_read_b128 v[64:67], v30 offset:18816
    v_exp_f32 v54, v54
    v_exp_f32 v55, v55
    s_setprio 0
    v_cvt_pk_bf16_f32 v50, v52, v53
    v_cvt_pk_bf16_f32 v51, v54, v55
    v_exp_f32 v56, v56
    v_exp_f32 v57, v57
    s_waitcnt lgkmcnt(3)
    v_mfma_f32_32x32x8_bf16 v[32:47], v[68:69], v[28:29], v[32:47]
    ds_read_b64 v[68:69], v71 offset:18816
    v_exp_f32 v58, v58
    v_exp_f32 v59, v59
    v_cvt_pk_bf16_f32 v56, v56, v57
    v_cvt_pk_bf16_f32 v57, v58, v59
    v_exp_f32 v60, v60
    s_add_u32 s70, s7, 196608
    buffer_load_dwordx4 v[96:99], v1, s[32:35], s70 offen offset:0 sc1
    v_exp_f32 v61, v61
    s_waitcnt lgkmcnt(3)
    v_mfma_f32_32x32x16_bf16 v[8:23], v[72:75], v[48:51], v[8:23]
    ds_read_b128 v[72:75], v70 offset:17408
    v_exp_f32 v62, v62
    v_exp_f32 v63, v63
    v_cvt_pk_bf16_f32 v58, v60, v61
    v_cvt_pk_bf16_f32 v59, v62, v63
    s_cmp_lg_u32 s44, 1
    s_cbranch_scc1 L_tm_21
    s_waitcnt vmcnt(7)
    s_barrier
L_tm_21:
    s_cmp_lg_u32 s44, 1
    s_cbranch_scc1 L_tm_22
    v_lshlrev_b32 v31, 15, v0
    s_mov_b64 exec, 15
    buffer_load_dword a127, v31, s[32:35], s3 offen sc1
    s_mov_b64 exec, 0xffffff
    v_lshlrev_b32 v31, 7, v0
    s_sub_u32 s70, s39, 12288
    buffer_load_dword a127, v31, s[32:35], s70 offen sc1
    buffer_load_dword a127, v31, s[32:35], s39 offen sc1
    s_mov_b64 exec, -1
L_tm_22:
    s_cmp_lg_u32 s44, 0
    s_cbranch_scc1 L_tm_23
    s_waitcnt vmcnt(7)
    s_barrier
L_tm_23:
    s_setprio 1
    s_cmp_lg_u32 s44, 0
    s_cbranch_scc1 L_tm_24
    s_setprio 3
L_tm_24:
    v_exp_f32 v32, v32
    v_exp_f32 v33, v33
    s_waitcnt lgkmcnt(3)
    v_mfma_f32_32x32x16_bf16 v[8:23], v[76:79], v[56:59], v[8:23]
    ds_read_b128 v[76:79], v70 offset:18112
    v_exp_f32 v34, v34
    v_exp_f32 v35, v35
    v_cvt_pk_bf16_f32 v32, v32, v33
    v_cvt_pk_bf16_f32 v33, v34, v35
    v_exp_f32 v36, v36
    s_add_u32 s70, s7, 0
    buffer_load_dwordx4 v[100:103], v1, s[32:35], s70 offen offset:1024 sc1
    v_exp_f32 v37, v37
    s_waitcnt lgkmcnt(3)
    v_mfma_f32_32x32x16_bf16 v[48:63], v[64:67], v[24:27], 0
    ds_read_b128 v[64:67], v30 offset:21504
    v_exp_f32 v38, v38
    v_exp_f32 v39, v39
    v_cvt_pk_bf16_f32 v34, v36, v37
    v_cvt_pk_bf16_f32 v35, v38, v39
    v_exp_f32 v40, v40
    v_exp_f32 v41, v41
    s_waitcnt lgkmcnt(3)
    v_mfma_f32_32x32x8_bf16 v[48:63], v[68:69], v[28:29], v[48:63]
    ds_read_b64 v[68:69], v71 offset:21504
    v_exp_f32 v42, v42
    v_exp_f32 v43, v43
    v_cvt_pk_bf16_f32 v40, v40, v41
    v_cvt_pk_bf16_f32 v41, v42, v43
    v_exp_f32 v44, v44
    s_add_u32 s70, s7, 49152
    buffer_load_dwordx4 v[104:107], v1, s[32:35], s70 offen offset:1024 sc1
    v_exp_f32 v45, v45
    s_waitcnt lgkmcnt(3)
    v_mfma_f32_32x32x16_bf16 v[8:23], v[72:75], v[32:35], v[8:23]
    ds_read_b128 v[72:75], v70 offset:20096
    v_exp_f32 v46, v46
    v_exp_f32 v47, v47
    v_cvt_pk_bf16_f32 v42, v44, v45
    v_cvt_pk_bf16_f32 v43, v46, v47
    v_exp_f32 v48, v48
    v_exp_f32 v49, v49
    s_waitcnt lgkmcnt(3)
    v_mfma_f32_32x32x16_bf16 v[8:23], v[76:79], v[40:43], v[8:23]
    ds_read_b128 v[76:79], v70 offset:20800
    v_exp_f32 v50, v50
    v_exp_f32 v51, v51
    v_cvt_pk_bf16_f32 v48, v48, v49
    v_cvt_pk_bf16_f32 v49, v50, v51
    v_exp_f32 v52, v52
    s_add_u32 s70, s7, 98304
    buffer_load_dwordx4 v[108:111], v1, s[32:35], s70 offen offset:1024 sc1
    v_exp_f32 v53, v53
    s_waitcnt lgkmcnt(3)
    v_mfma_f32_32x32x16_bf16 v[32:47], v[64:67], v[24:27], 0
    ds_read_b128 v[64:67], v30 offset:24192
    v_exp_f32 v54, v54
    v_exp_f32 v55, v55
    v_cvt_pk_bf16_f32 v50, v52, v53
    v_cvt_pk_bf16_f32 v51, v54, v55
    v_exp_f32 v56, v56
    v_exp_f32 v57, v57
    s_waitcnt lgkmcnt(3)
    v_mfma_f32_32x32x8_bf16 v[32:47], v[68:69], v[28:29], v[32:47]
    ds_read_b64 v[68:69], v71 offset:24192
    v_exp_f32 v58, v58
    v_exp_f32 v59, v59
    v_cvt_pk_bf16_f32 v56, v56, v57
    v_cvt_pk_bf16_f32 v57, v58, v59
    v_exp_f32 v60, v60
    s_add_u32 s70, s7, 147456
    buffer_load_dwordx4 v[112:115], v1, s[32:35], s70 offen offset:1024 sc1
    v_exp_f32 v61, v61
    s_waitcnt lgkmcnt(3)
    v_mfma_f32_32x32x16_bf16 v[8:23], v[72:75], v[48:51], v[8:23]
    ds_read_b128 v[72:75], v70 offset:22784
    v_exp_f32 v62, v62
    v_exp_f32 v63, v63
    v_cvt_pk_bf16_f32 v58, v60, v61
    v_cvt_pk_bf16_f32 v59, v62, v63
    v_exp_f32 v32, v32
    v_exp_f32 v33, v33
    s_waitcnt lgkmcnt(3)
    v_mfma_f32_32x32x16_bf16 v[8:23], v[76:79], v[56:59], v[8:23]
    ds_read_b128 v[76:79], v70 offset:23488
    v_exp_f32 v34, v34
    v_exp_f32 v35, v35
    v_cvt_pk_bf16_f32 v32, v32, v33
    v_cvt_pk_bf16_f32 v33, v34, v35
    v_exp_f32 v36, v36
    s_add_u32 s70, s7, 196608
    buffer_load_dwordx4 v[116:119], v1, s[32:35], s70 offen offset:1024 sc1
    v_exp_f32 v37, v37
    s_waitcnt lgkmcnt(3)
    v_mfma_f32_32x32x16_bf16 v[48:63], v[64:67], v[24:27], 0
    ds_read_b128 v[64:67], v30 offset:26880
    v_exp_f32 v38, v38
    v_exp_f32 v39, v39
    v_cvt_pk_bf16_f32 v34, v36, v37
    v_cvt_pk_bf16_f32 v35, v38, v39
    v_exp_f32 v40, v40
    v_exp_f32 v41, v41
    s_waitcnt lgkmcnt(3)
    v_mfma_f32_32x32x8_bf16 v[48:63], v[68:69], v[28:29], v[48:63]
    ds_read_b64 v[68:69], v71 offset:26880
    v_exp_f32 v42, v42
    v_exp_f32 v43, v43
    v_cvt_pk_bf16_f32 v40, v40, v41
    v_cvt_pk_bf16_f32 v41, v42, v43
    v_exp_f32 v44, v44
    s_add_u32 s70, s7, 0
    buffer_load_dwordx4 v[120:123], v1, s[32:35], s70 offen offset:2048 sc1
    v_exp_f32 v45, v45
    s_waitcnt lgkmcnt(3)
    v_mfma_f32_32x32x16_bf16 v[8:23], v[72:75], v[32:35], v[8:23]
    ds_read_b128 v[72:75], v70 offset:25472
    v_exp_f32 v46, v46
    v_exp_f32 v47, v47
    v_cvt_pk_bf16_f32 v42, v44, v45
    v_cvt_pk_bf16_f32 v43, v46, v47
    v_exp_f32 v48, v48
    v_exp_f32 v49, v49
    s_waitcnt lgkmcnt(3)
    v_mfma_f32_32x32x16_bf16 v[8:23], v[76:79], v[40:43], v[8:23]
    ds_read_b128 v[76:79], v70 offset:26176
    v_exp_f32 v50, v50
    v_exp_f32 v51, v51
    v_cvt_pk_bf16_f32 v48, v48, v49
    v_cvt_pk_bf16_f32 v49, v50, v51
    v_exp_f32 v52, v52
    s_add_u32 s70, s7, 49152
    buffer_load_dwordx4 v[124:127], v1, s[32:35], s70 offen offset:2048 sc1
    v_exp_f32 v53, v53
    s_waitcnt lgkmcnt(3)
    v_mfma_f32_32x32x16_bf16 v[32:47], v[64:67], v[24:27], 0
    ds_read_b128 v[64:67], v30 offset:29568
    v_exp_f32 v54, v54
    v_exp_f32 v55, v55
    v_cvt_pk_bf16_f32 v50, v52, v53
    v_cvt_pk_bf16_f32 v51, v54, v55
    v_exp_f32 v56, v56
    v_exp_f32 v57, v57
    s_waitcnt lgkmcnt(3)
    v_mfma_f32_32x32x8_bf16 v[32:47], v[68:69], v[28:29], v[32:47]
    ds_read_b64 v[68:69], v71 offset:29568
    v_exp_f32 v58, v58
    v_exp_f32 v59, v59
    v_cvt_pk_bf16_f32 v56, v56, v57
    v_cvt_pk_bf16_f32 v57, v58, v59
    v_exp_f32 v60, v60
    v_exp_f32 v61, v61
    s_waitcnt lgkmcnt(3)
    v_mfma_f32_32x32x16_bf16 v[8:23], v[72:75], v[48:51], v[8:23]
    ds_read_b128 v[72:75], v70 offset:28160
    v_exp_f32 v62, v62
    v_exp_f32 v63, v63
    v_cvt_pk_bf16_f32 v58, v60, v61
    v_cvt_pk_bf16_f32 v59, v62, v63
    v_exp_f32 v32, v32
    v_exp_f32 v33, v33
    s_waitcnt lgkmcnt(3)
    v_mfma_f32_32x32x16_bf16 v[8:23], v[76:79], v[56:59], v[8:23]
    ds_read_b128 v[76:79], v70 offset:28864
    v_exp_f32 v34, v34
    v_exp_f32 v35, v35
    v_cvt_pk_bf16_f32 v32, v32, v33
    v_cvt_pk_bf16_f32 v33, v34, v35
    v_exp_f32 v36, v36
    v_exp_f32 v37, v37
    s_waitcnt lgkmcnt(3)
    v_mfma_f32_32x32x16_bf16 v[48:63], v[64:67], v[24:27], 0
    ds_read_b128 v[64:67], v30 offset:32256
    v_exp_f32 v38, v38
    v_exp_f32 v39, v39
    v_cvt_pk_bf16_f32 v34, v36, v37
    v_cvt_pk_bf16_f32 v35, v38, v39
    v_exp_f32 v40, v40
    v_exp_f32 v41, v41
    s_waitcnt lgkmcnt(3)
    v_mfma_f32_32x32x8_bf16 v[48:63], v[68:69], v[28:29], v[48:63]
    ds_read_b64 v[68:69], v71 offset:32256
    v_exp_f32 v42, v42
    v_exp_f32 v43, v43
    v_cvt_pk_bf16_f32 v40, v40, v41
    v_cvt_pk_bf16_f32 v41, v42, v43
    v_exp_f32 v44, v44
    v_exp_f32 v45, v45
    s_waitcnt lgkmcnt(3)
    v_mfma_f32_32x32x16_bf16 v[8:23], v[72:75], v[32:35], v[8:23]
    ds_read_b128 v[72:75], v70 offset:30848
    v_exp_f32 v46, v46
    v_exp_f32 v47, v47
    v_cvt_pk_bf16_f32 v42, v44, v45
    v_cvt_pk_bf16_f32 v43, v46, v47
    v_exp_f32 v48, v48
    v_exp_f32 v49, v49
    s_waitcnt lgkmcnt(3)
    v_mfma_f32_32x32x16_bf16 v[8:23], v[76:79], v[40:43], v[8:23]
    ds_read_b128 v[76:79], v70 offset:31552
    v_exp_f32 v50, v50
    v_exp_f32 v51, v51
    v_cvt_pk_bf16_f32 v48, v48, v49
    v_cvt_pk_bf16_f32 v49, v50, v51
    v_exp_f32 v52, v52
    v_exp_f32 v53, v53
    s_waitcnt lgkmcnt(3)
    v_mfma_f32_32x32x16_bf16 v[32:47], v[64:67], v[24:27], 0
    ds_read_b128 v[64:67], v30 offset:34944
    v_exp_f32 v54, v54
    v_exp_f32 v55, v55
    v_cvt_pk_bf16_f32 v50, v52, v53
    v_cvt_pk_bf16_f32 v51, v54, v55
    v_exp_f32 v56, v56
    v_exp_f32 v57, v57
    s_waitcnt lgkmcnt(3)
    v_mfma_f32_32x32x8_bf16 v[32:47], v[68:69], v[28:29], v[32:47]
    ds_read_b64 v[68:69], v71 offset:34944
    v_exp_f32 v58, v58
    v_exp_f32 v59, v59
    v_cvt_pk_bf16_f32 v56, v56, v57
    v_cvt_pk_bf16_f32 v57, v58, v59
    v_exp_f32 v60, v60
    v_exp_f32 v61, v61
    s_waitcnt lgkmcnt(3)
    v_mfma_f32_32x32x16_bf16 v[8:23], v[72:75], v[48:51], v[8:23]
    ds_read_b128 v[72:75], v70 offset:33536
    v_exp_f32 v62, v62
    v_exp_f32 v63, v63
    v_cvt_pk_bf16_f32 v58, v60, v61
    v_cvt_pk_bf16_f32 v59, v62, v63
    v_exp_f32 v32, v32
    v_exp_f32 v33, v33
    s_waitcnt lgkmcnt(3)
    v_mfma_f32_32x32x16_bf16 v[8:23], v[76:79], v[56:59], v[8:23]
    ds_read_b128 v[76:79], v70 offset:34240
    v_exp_f32 v34, v34
    v_exp_f32 v35, v35
    v_cvt_pk_bf16_f32 v32, v32, v33
    v_cvt_pk_bf16_f32 v33, v34, v35
    v_exp_f32 v36, v36
    v_exp_f32 v37, v37
    s_waitcnt lgkmcnt(3)
    v_mfma_f32_32x32x16_bf16 v[48:63], v[64:67], v[24:27], 0
    ds_read_b128 v[64:67], v30 offset:37632
    v_exp_f32 v38, v38
    v_exp_f32 v39, v39
    v_cvt_pk_bf16_f32 v34, v36, v37
    v_cvt_pk_bf16_f32 v35, v38, v39
    v_exp_f32 v40, v40
    v_exp_f32 v41, v41
    s_waitcnt lgkmcnt(3)
    v_mfma_f32_32x32x8_bf16 v[48:63], v[68:69], v[28:29], v[48:63]
    ds_read_b64 v[68:69], v71 offset:37632
    v_exp_f32 v42, v42
    v_exp_f32 v43, v43
    v_cvt_pk_bf16_f32 v40, v40, v41
    v_cvt_pk_bf16_f32 v41, v42, v43
    v_exp_f32 v44, v44
    v_exp_f32 v45, v45
    s_waitcnt lgkmcnt(3)
    v_mfma_f32_32x32x16_bf16 v[8:23], v[72:75], v[32:35], v[8:23]
    ds_read_b128 v[72:75], v70 offset:36224
    v_exp_f32 v46, v46
    v_exp_f32 v47, v47
    v_cvt_pk_bf16_f32 v42, v44, v45
    v_cvt_pk_bf16_f32 v43, v46, v47
    v_exp_f32 v48, v48
    v_exp_f32 v49, v49
    s_waitcnt lgkmcnt(3)
    v_mfma_f32_32x32x16_bf16 v[8:23], v[76:79], v[40:43], v[8:23]
    ds_read_b128 v[76:79], v70 offset:36928
    v_exp_f32 v50, v50
    v_exp_f32 v51, v51
    v_cvt_pk_bf16_f32 v48, v48, v49
    v_cvt_pk_bf16_f32 v49, v50, v51
    v_exp_f32 v52, v52
    v_exp_f32 v53, v53
    s_waitcnt lgkmcnt(3)
    v_mfma_f32_32x32x16_bf16 v[32:47], v[64:67], v[24:27], 0
    ds_read_b128 v[64:67], v30 offset:40320
    v_exp_f32 v54, v54
    v_exp_f32 v55, v55
    v_cvt_pk_bf16_f32 v50, v52, v53
    v_cvt_pk_bf16_f32 v51, v54, v55
    v_exp_f32 v56, v56
    v_exp_f32 v57, v57
    s_waitcnt lgkmcnt(3)
    v_mfma_f32_32x32x8_bf16 v[32:47], v[68:69], v[28:29], v[32:47]
    ds_read_b64 v[68:69], v71 offset:40320
    v_exp_f32 v58, v58
    v_exp_f32 v59, v59
    v_cvt_pk_bf16_f32 v56, v56, v57
    v_cvt_pk_bf16_f32 v57, v58, v59
    v_exp_f32 v60, v60
    v_exp_f32 v61, v61
    s_waitcnt lgkmcnt(3)
    v_mfma_f32_32x32x16_bf16 v[8:23], v[72:75], v[48:51], v[8:23]
    ds_read_b128 v[72:75], v70 offset:38912
    v_exp_f32 v62, v62
    v_exp_f32 v63, v63
    v_cvt_pk_bf16_f32 v58, v60, v61
    v_cvt_pk_bf16_f32 v59, v62, v63
    v_exp_f32 v32, v32
    v_exp_f32 v33, v33
    s_waitcnt lgkmcnt(3)
    v_mfma_f32_32x32x16_bf16 v[8:23], v[76:79], v[56:59], v[8:23]
    ds_read_b128 v[76:79], v70 offset:39616
    v_exp_f32 v34, v34
    v_exp_f32 v35, v35
    v_cvt_pk_bf16_f32 v32, v32, v33
    v_cvt_pk_bf16_f32 v33, v34, v35
    v_exp_f32 v36, v36
    v_exp_f32 v37, v37
    s_waitcnt lgkmcnt(3)
    v_mfma_f32_32x32x16_bf16 v[48:63], v[64:67], v[24:27], 0
    v_exp_f32 v38, v38
    v_exp_f32 v39, v39
    v_cvt_pk_bf16_f32 v34, v36, v37
    v_cvt_pk_bf16_f32 v35, v38, v39
    v_exp_f32 v40, v40
    v_exp_f32 v41, v41
    s_waitcnt lgkmcnt(2)
    v_mfma_f32_32x32x8_bf16 v[48:63], v[68:69], v[28:29], v[48:63]
    v_exp_f32 v42, v42
    v_exp_f32 v43, v43
    v_cvt_pk_bf16_f32 v40, v40, v41
    v_cvt_pk_bf16_f32 v41, v42, v43
    v_exp_f32 v44, v44
    v_exp_f32 v45, v45
    s_waitcnt lgkmcnt(1)
    v_mfma_f32_32x32x16_bf16 v[8:23], v[72:75], v[32:35], v[8:23]
    ds_read_b128 v[72:75], v70 offset:41600
    v_exp_f32 v46, v46
    v_exp_f32 v47, v47
    v_cvt_pk_bf16_f32 v42, v44, v45
    v_cvt_pk_bf16_f32 v43, v46, v47
    v_exp_f32 v48, v48
    v_exp_f32 v49, v49
    s_waitcnt lgkmcnt(1)
    v_mfma_f32_32x32x16_bf16 v[8:23], v[76:79], v[40:43], v[8:23]
    ds_read_b128 v[76:79], v70 offset:42304
    v_exp_f32 v50, v50
    v_exp_f32 v51, v51
    v_cvt_pk_bf16_f32 v48, v48, v49
    v_cvt_pk_bf16_f32 v49, v50, v51
    v_exp_f32 v52, v52
    s_cmp_lg_u32 s44, 0
    s_cbranch_scc1 L_tm_25
    v_and_b32 v31, 7, v0
    v_lshlrev_b32 v31, 6, v31
    v_and_or_b32 v31, v0, 48, v31
    s_lshl_b32 s70, s37, 2
    s_add_u32 s70, s70, s45
    s_mul_i32 s70, s70, 1536
    s_add_u32 s71, s70, 524288
    buffer_load_dwordx4 v[24:27], v31, s[32:35], s71 offen offset:0 sc1
    buffer_load_dwordx4 v[44:47], v31, s[32:35], s71 offen offset:512 sc1
    buffer_load_dwordx4 v[64:67], v31, s[32:35], s71 offen offset:1024 sc1
L_tm_25:
    v_exp_f32 v53, v53
    v_exp_f32 v54, v54
    v_exp_f32 v55, v55
    v_cvt_pk_bf16_f32 v50, v52, v53
    v_cvt_pk_bf16_f32 v51, v54, v55
    v_exp_f32 v56, v56
    v_exp_f32 v57, v57
    v_exp_f32 v58, v58
    v_exp_f32 v59, v59
    v_cvt_pk_bf16_f32 v56, v56, v57
    v_cvt_pk_bf16_f32 v57, v58, v59
    v_exp_f32 v60, v60
    v_exp_f32 v61, v61
    s_waitcnt lgkmcnt(1)
    v_mfma_f32_32x32x16_bf16 v[8:23], v[72:75], v[48:51], v[8:23]
    v_exp_f32 v62, v62
    v_exp_f32 v63, v63
    v_cvt_pk_bf16_f32 v58, v60, v61
    v_cvt_pk_bf16_f32 v59, v62, v63
    s_waitcnt lgkmcnt(0)
    s_nop 0
    v_mfma_f32_32x32x16_bf16 v[8:23], v[76:79], v[56:59], v[8:23]
L_attn_done:
    v_and_b32 v33, 15, v0
    v_lshlrev_b32 v33, 4, v33
    v_lshrrev_b32 v34, 5, v0
    v_lshlrev_b32 v34, 8, v34
    v_bfe_u32 v32, v0, 4, 1
    v_mul_u32_u24 v32, 20480, v32
    v_add_u32 v32, v32, v33
    v_add_u32 v31, v33, v34
    v_add_u32 v33, v32, v34
    v_mov_b32 v28, s40
    v_mov_b32 v29, s41
    s_nop 0
    v_mov_b32 v34, v16
    v_mov_b32 v35, v16
    s_nop 1
    v_permlane32_swap_b32 v34, v35
    v_rcp_f32 v34, v35
    s_nop 0
    v_mul_f32 v8, v8, v34
    v_mul_f32 v9, v9, v34
    v_mul_f32 v10, v10, v34
    v_mul_f32 v11, v11, v34
    v_mul_f32 v12, v12, v34
    v_mul_f32 v13, v13, v34
    v_mul_f32 v14, v14, v34
    v_mul_f32 v15, v15, v34
    v_mul_f32 v16, v16, v34
    v_mul_f32 v17, v17, v34
    v_mul_f32 v18, v18, v34
    v_mul_f32 v19, v19, v34
    v_cvt_pk_bf16_f32 v36, v8, v9
    v_cvt_pk_bf16_f32 v37, v10, v11
    v_cvt_pk_bf16_f32 v38, v12, v13
    v_cvt_pk_bf16_f32 v39, v14, v15
    v_cvt_pk_bf16_f32 v40, v16, v17
    v_cvt_pk_bf16_f32 v41, v18, v19
    s_cmp_eq_u32 s4, 0
    s_cbranch_scc1 L_st_26_s
    buffer_store_dwordx4 v[36:39], v33, s[32:35], s48 offen
L_st_26_b:
    s_mov_b32 exec_hi, 0
    s_cmp_eq_u32 s4, 0
    s_cbranch_scc1 L_st_27_s
    buffer_store_dwordx2 v[40:41], v32, s[32:35], s49 offen
L_st_27_b:
    s_mov_b64 exec, -1
    v_mov_b32 v43, 159872
    v_mov_b32 v42, s44
    s_mov_b64 exec, 1
    ds_add_u32 v43, v42 offset:8
    s_mov_b64 exec, -1
    s_mul_i32 s70, s43, 10240
    s_mul_i32 s71, s43, 40960
    s_add_u32 s72, s70, s71
    v_add_u32 v69, s72, v1
    s_add_u32 s72, s70, 81920
    v_add_u32 v70, s72, v1
    s_sub_u32 s72, 40960, s71
    s_add_u32 s72, s72, s70
    v_add_u32 v71, s72, v1
    v_bfe_u32 v30, v0, 2, 3
    v_lshlrev_b32 v30, 7, v30
    v_and_b32 v42, 3, v0
    v_lshl_add_u32 v30, v42, 3, v30
    s_lshl_b32 s73, s36, 10
    s_lshl_b32 s70, s44, 5
    s_add_u32 s74, s73, s70
    s_add_u32 s74, s74, 65536
    v_lshlrev_b32 v48, 16, v2
    v_and_b32 v49, 0xffff0000, v2
    v_lshlrev_b32 v50, 16, v3
    v_and_b32 v51, 0xffff0000, v3
    v_lshlrev_b32 v52, 16, v4
    v_and_b32 v53, 0xffff0000, v4
    v_lshlrev_b32 v54, 16, v5
    v_and_b32 v55, 0xffff0000, v5
    v_lshlrev_b32 v56, 16, v6
    v_and_b32 v57, 0xffff0000, v6
    v_lshlrev_b32 v58, 16, v7
    v_and_b32 v59, 0xffff0000, v7
    s_cmp_lg_u32 s43, 1
    s_cbranch_scc1 L_tm_28
    v_mov_b32 v56, 0
    v_mov_b32 v57, 0
    v_mov_b32 v58, 0
    v_mov_b32 v59, 0
L_tm_28:
    s_waitcnt vmcnt(0)
    s_add_u32 s70, s3, 0
    s_mov_b64 exec, 1
    s_cmp_eq_u32 s4, 0
    s_cbranch_scc1 L_st_29_s
    buffer_store_dwordx2 v[28:29], off, s[32:35], s70
L_st_29_b:
    s_mov_b64 exec, -1
    s_cmp_lg_u32 s44, 0
    s_cbranch_scc1 L_tm_30
    s_mul_i32 s70, s45, 192
    s_add_u32 s70, s70, 160768
    v_and_b32 v42, 48, v0
    v_add_u32 v42, s70, v42
    v_add_f32_dpp v24, v24, v24 row_ror:4 row_mask:0xf bank_mask:0xf
    v_add_f32_dpp v25, v25, v25 row_ror:4 row_mask:0xf bank_mask:0xf
    v_add_f32_dpp v26, v26, v26 row_ror:4 row_mask:0xf bank_mask:0xf
    v_add_f32_dpp v27, v27, v27 row_ror:4 row_mask:0xf bank_mask:0xf
    v_add_f32_dpp v44, v44, v44 row_ror:4 row_mask:0xf bank_mask:0xf
    v_add_f32_dpp v45, v45, v45 row_ror:4 row_mask:0xf bank_mask:0xf
    v_add_f32_dpp v46, v46, v46 row_ror:4 row_mask:0xf bank_mask:0xf
    v_add_f32_dpp v47, v47, v47 row_ror:4 row_mask:0xf bank_mask:0xf
    v_add_f32_dpp v64, v64, v64 row_ror:4 row_mask:0xf bank_mask:0xf
    v_add_f32_dpp v65, v65, v65 row_ror:4 row_mask:0xf bank_mask:0xf
    v_add_f32_dpp v66, v66, v66 row_ror:4 row_mask:0xf bank_mask:0xf
    v_add_f32_dpp v67, v67, v67 row_ror:4 row_mask:0xf bank_mask:0xf
    v_add_f32_dpp v24, v24, v24 row_ror:2 row_mask:0xf bank_mask:0xf
    v_add_f32_dpp v25, v25, v25 row_ror:2 row_mask:0xf bank_mask:0xf
    v_add_f32_dpp v26, v26, v26 row_ror:2 row_mask:0xf bank_mask:0xf
    v_add_f32_dpp v27, v27, v27 row_ror:2 row_mask:0xf bank_mask:0xf
    v_add_f32_dpp v44, v44, v44 row_ror:2 row_mask:0xf bank_mask:0xf
    v_add_f32_dpp v45, v45, v45 row_ror:2 row_mask:0xf bank_mask:0xf
    v_add_f32_dpp v46, v46, v46 row_ror:2 row_mask:0xf bank_mask:0xf
    v_add_f32_dpp v47, v47, v47 row_ror:2 row_mask:0xf bank_mask:0xf
    v_add_f32_dpp v64, v64, v64 row_ror:2 row_mask:0xf bank_mask:0xf
    v_add_f32_dpp v65, v65, v65 row_ror:2 row_mask:0xf bank_mask:0xf
    v_add_f32_dpp v66, v66, v66 row_ror:2 row_mask:0xf bank_mask:0xf
    v_add_f32_dpp v67, v67, v67 row_ror:2 row_mask:0xf bank_mask:0xf
    v_add_f32_dpp v24, v24, v24 row_ror:1 row_mask:0xf bank_mask:0xf
    v_add_f32_dpp v25, v25, v25 row_ror:1 row_mask:0xf bank_mask:0xf
    v_add_f32_dpp v26, v26, v26 row_ror:1 row_mask:0xf bank_mask:0xf
    v_add_f32_dpp v27, v27, v27 row_ror:1 row_mask:0xf bank_mask:0xf
    v_add_f32_dpp v44, v44, v44 row_ror:1 row_mask:0xf bank_mask:0xf
    v_add_f32_dpp v45, v45, v45 row_ror:1 row_mask:0xf bank_mask:0xf
    v_add_f32_dpp v46, v46, v46 row_ror:1 row_mask:0xf bank_mask:0xf
    v_add_f32_dpp v47, v47, v47 row_ror:1 row_mask:0xf bank_mask:0xf
    v_add_f32_dpp v64, v64, v64 row_ror:1 row_mask:0xf bank_mask:0xf
    v_add_f32_dpp v65, v65, v65 row_ror:1 row_mask:0xf bank_mask:0xf
    v_add_f32_dpp v66, v66, v66 row_ror:1 row_mask:0xf bank_mask:0xf
    v_add_f32_dpp v67, v67, v67 row_ror:1 row_mask:0xf bank_mask:0xf
    s_mov_b64 exec, 0x10001
    s_mov_b32 exec_hi, 0x10001
    ds_write_b128 v42, v[24:27] offset:0
    ds_write_b128 v42, v[44:47] offset:64
    ds_write_b128 v42, v[64:67] offset:128
    s_mov_b64 exec, -1
L_tm_30:
    ds_read_b128 v[72:75], v71 offset:0
    ds_read_b128 v[76:79], v71 offset:20480
    ds_read_b128 a[120:123], v70 offset:0
    ds_read_b128 a[124:127], v69 offset:0
    ds_read_b128 v[44:47], v69 offset:20480
    ds_read_b128 v[40:43], v71 offset:1024
    ds_read_b128 v[36:39], v71 offset:21504
    s_mov_b32 s70, 145408
    s_mul_i32 s71, s45, 3072
    s_add_u32 s20, s71, s70
    v_add_u32 v68, s20, v1
    s_xor_b32 s71, s45, 2
    s_mul_i32 s71, s71, 3072
    s_add_u32 s21, s71, s70
    s_lshl_b32 s22, s38, 2
    s_add_u32 s22, s22, 159904
    s_mul_i32 s70, s44, 30720
    s_add_u32 s23, s70, 102400
    s_mul_i32 s70, s44, 10240
    s_sub_u32 s80, 122880, s70
    s_mul_i32 s70, s38, 3072
    s_add_u32 s81, s70, 40960
    s_xor_b32 s70, s38, 4
    s_mul_i32 s70, s70, 3072
    s_add_u32 s82, s70, 40960
    s_mul_i32 s70, s45, 192
    s_add_u32 s83, s70, 160768
    s_and_b32 s71, s38, 1
    s_lshl_b32 s70, s71, 7
    s_add_u32 s84, s70, 160256
    s_lshl_b32 s70, s44, 7
    s_add_u32 s85, s70, 160000
    s_lshl_b32 s70, s71, 11
    s_add_u32 s70, s70, s6
    s_add_u32 s86, s70, 86016
    s_mov_b32 s79, 0x200000
L_poll_31:
    buffer_load_dwordx2 v[26:27], v30, s[32:35], s74 offen sc1
    s_sub_u32 s79, s79, 1
    s_cbranch_scc1 L_poll_31_d
    s_waitcnt vmcnt(0)
    v_cmp_ne_u64 vcc, s[40:41], v[26:27]
    s_cbranch_vccnz L_poll_31
L_poll_31_d:
    buffer_load_dwordx4 v[8:11], v1, s[32:35], s50 offen offset:0 sc1
    buffer_load_dwordx4 v[12:15], v1, s[32:35], s50 offen offset:1024 sc1
    buffer_load_dwordx4 v[16:19], v1, s[32:35], s50 offen offset:2048 sc1
    buffer_load_dwordx4 v[20:23], v1, s[32:35], s50 offen offset:3072 sc1
    buffer_load_dwordx4 v[24:27], v1, s[32:35], s51 offen offset:0 sc1
    s_add_u32 s74, s73, 98336
    s_cmp_lg_u32 s44, 1
    s_cbranch_scc1 L_tm_32
    v_mov_b32 v64, 159872
    s_mov_b32 s79, 0x200000
L_lw_33:
    ds_read_b32 v65, v64 offset:12
    s_sub_u32 s79, s79, 1
    s_cbranch_scc1 L_lw_33_d
    s_waitcnt lgkmcnt(0)
    v_cmp_gt_u32 vcc, 4, v65
    s_cbranch_vccnz L_lw_33
L_lw_33_d:
L_tm_32:
    ds_read_b128 v[32:35], v70 offset:1024
    s_waitcnt vmcnt(4)
    s_waitcnt lgkmcnt(6)
    v_mfma_f32_16x16x32_bf16 v[60:63], v[72:75], v[8:11], 0
    ds_read_b128 v[72:75], v69 offset:1024
    v_mfma_f32_16x16x32_bf16 v[64:67], v[76:79], v[8:11], 0
    ds_read_b128 v[76:79], v69 offset:21504
    s_waitcnt lgkmcnt(6)
    v_mfma_f32_16x16x32_bf16 v[56:59], a[120:123], v[8:11], v[56:59]
    ds_read_b128 a[120:123], v71 offset:2048
    v_mfma_f32_16x16x32_bf16 v[48:51], a[124:127], v[8:11], v[48:51]
    ds_read_b128 a[124:127], v71 offset:22528
    s_waitcnt lgkmcnt(6)
    v_mfma_f32_16x16x32_bf16 v[52:55], v[44:47], v[8:11], v[52:55]
    buffer_load_dwordx4 v[8:11], v1, s[32:35], s51 offen offset:1024 sc1
    ds_read_b128 v[44:47], v70 offset:2048
    s_waitcnt vmcnt(4)
    v_mfma_f32_16x16x32_bf16 v[60:63], v[40:43], v[12:15], v[60:63]
    ds_read_b128 v[40:43], v69 offset:2048
    s_waitcnt lgkmcnt(6)
    v_mfma_f32_16x16x32_bf16 v[64:67], v[36:39], v[12:15], v[64:67]
    ds_read_b128 v[36:39], v69 offset:22528
    v_mfma_f32_16x16x32_bf16 v[56:59], v[32:35], v[12:15], v[56:59]
    ds_read_b128 v[32:35], v71 offset:3072
    s_waitcnt lgkmcnt(6)
    v_mfma_f32_16x16x32_bf16 v[48:51], v[72:75], v[12:15], v[48:51]
    ds_read_b128 v[72:75], v71 offset:23552
    v_mfma_f32_16x16x32_bf16 v[52:55], v[76:79], v[12:15], v[52:55]
    buffer_load_dwordx4 v[12:15], v1, s[32:35], s51 offen offset:2048 sc1
    ds_read_b128 v[76:79], v70 offset:3072
    s_waitcnt vmcnt(4)
    s_waitcnt lgkmcnt(6)
    v_mfma_f32_16x16x32_bf16 v[60:63], a[120:123], v[16:19], v[60:63]
    ds_read_b128 a[120:123], v69 offset:3072
    v_mfma_f32_16x16x32_bf16 v[64:67], a[124:127], v[16:19], v[64:67]
    ds_read_b128 a[124:127], v69 offset:23552
    s_waitcnt lgkmcnt(6)
    v_mfma_f32_16x16x32_bf16 v[56:59], v[44:47], v[16:19], v[56:59]
    ds_read_b128 v[44:47], v71 offset:4096
    v_mfma_f32_16x16x32_bf16 v[48:51], v[40:43], v[16:19], v[48:51]
    ds_read_b128 v[40:43], v71 offset:24576
    s_waitcnt lgkmcnt(6)
    v_mfma_f32_16x16x32_bf16 v[52:55], v[36:39], v[16:19], v[52:55]
    buffer_load_dwordx4 v[16:19], v1, s[32:35], s51 offen offset:3072 sc1
    ds_read_b128 v[36:39], v70 offset:4096
    s_waitcnt vmcnt(4)
    v_mfma_f32_16x16x32_bf16 v[60:63], v[32:35], v[20:23], v[60:63]
    ds_read_b128 v[32:35], v69 offset:4096
    s_waitcnt lgkmcnt(6)
    v_mfma_f32_16x16x32_bf16 v[64:67], v[72:75], v[20:23], v[64:67]
    ds_read_b128 v[72:75], v69 offset:24576
    v_mfma_f32_16x16x32_bf16 v[56:59], v[76:79], v[20:23], v[56:59]
    ds_read_b128 v[76:79], v71 offset:5120
    s_waitcnt lgkmcnt(6)
    v_mfma_f32_16x16x32_bf16 v[48:51], a[120:123], v[20:23], v[48:51]
    ds_read_b128 a[120:123], v71 offset:25600
    v_mfma_f32_16x16x32_bf16 v[52:55], a[124:127], v[20:23], v[52:55]
    buffer_load_dwordx4 v[20:23], v1, s[32:35], s52 offen offset:0 sc1
    ds_read_b128 a[124:127], v70 offset:5120
    s_waitcnt vmcnt(4)
    s_waitcnt lgkmcnt(6)
    v_mfma_f32_16x16x32_bf16 v[60:63], v[44:47], v[24:27], v[60:63]
    ds_read_b128 v[44:47], v69 offset:5120
    v_mfma_f32_16x16x32_bf16 v[64:67], v[40:43], v[24:27], v[64:67]
    ds_read_b128 v[40:43], v69 offset:25600
    s_waitcnt lgkmcnt(6)
    v_mfma_f32_16x16x32_bf16 v[56:59], v[36:39], v[24:27], v[56:59]
    ds_read_b128 v[36:39], v71 offset:6144
    v_mfma_f32_16x16x32_bf16 v[48:51], v[32:35], v[24:27], v[48:51]
    ds_read_b128 v[32:35], v71 offset:26624
    s_waitcnt lgkmcnt(6)
    v_mfma_f32_16x16x32_bf16 v[52:55], v[72:75], v[24:27], v[52:55]
    buffer_load_dwordx4 v[24:27], v1, s[32:35], s52 offen offset:1024 sc1
    ds_read_b128 v[72:75], v70 offset:6144
    s_waitcnt vmcnt(4)
    v_mfma_f32_16x16x32_bf16 v[60:63], v[76:79], v[8:11], v[60:63]
    ds_read_b128 v[76:79], v69 offset:6144
    s_waitcnt lgkmcnt(6)
    v_mfma_f32_16x16x32_bf16 v[64:67], a[120:123], v[8:11], v[64:67]
    ds_read_b128 a[120:123], v69 offset:26624
    v_mfma_f32_16x16x32_bf16 v[56:59], a[124:127], v[8:11], v[56:59]
    ds_read_b128 a[124:127], v71 offset:7168
    s_waitcnt lgkmcnt(6)
    v_mfma_f32_16x16x32_bf16 v[48:51], v[44:47], v[8:11], v[48:51]
    ds_read_b128 v[44:47], v71 offset:27648
    v_mfma_f32_16x16x32_bf16 v[52:55], v[40:43], v[8:11], v[52:55]
    ds_read_b128 v[40:43], v70 offset:7168
    s_waitcnt vmcnt(3)
    s_waitcnt lgkmcnt(6)
    v_mfma_f32_16x16x32_bf16 v[60:63], v[36:39], v[12:15], v[60:63]
    ds_read_b128 v[36:39], v69 offset:7168
    v_mfma_f32_16x16x32_bf16 v[64:67], v[32:35], v[12:15], v[64:67]
    ds_read_b128 v[32:35], v69 offset:27648
    s_waitcnt lgkmcnt(6)
    v_mfma_f32_16x16x32_bf16 v[56:59], v[72:75], v[12:15], v[56:59]
    ds_read_b128 v[72:75], v71 offset:8192
    v_mfma_f32_16x16x32_bf16 v[48:51], v[76:79], v[12:15], v[48:51]
    ds_read_b128 v[76:79], v71 offset:28672
    s_waitcnt lgkmcnt(6)
    v_mfma_f32_16x16x32_bf16 v[52:55], a[120:123], v[12:15], v[52:55]
    ds_read_b128 a[120:123], v70 offset:8192
    s_waitcnt vmcnt(2)
    v_mfma_f32_16x16x32_bf16 v[60:63], a[124:127], v[16:19], v[60:63]
    ds_read_b128 a[124:127], v69 offset:8192
    s_waitcnt lgkmcnt(6)
    v_mfma_f32_16x16x32_bf16 v[64:67], v[44:47], v[16:19], v[64:67]
    ds_read_b128 v[44:47], v69 offset:28672
    v_mfma_f32_16x16x32_bf16 v[56:59], v[40:43], v[16:19], v[56:59]
    ds_read_b128 v[40:43], v71 offset:9216
    s_waitcnt lgkmcnt(6)
    v_mfma_f32_16x16x32_bf16 v[48:51], v[36:39], v[16:19], v[48:51]
    ds_read_b128 v[36:39], v71 offset:29696
    v_mfma_f32_16x16x32_bf16 v[52:55], v[32:35], v[16:19], v[52:55]
    ds_read_b128 v[32:35], v70 offset:9216
    s_waitcnt vmcnt(1)
    s_waitcnt lgkmcnt(6)
    v_mfma_f32_16x16x32_bf16 v[60:63], v[72:75], v[20:23], v[60:63]
    ds_read_b128 v[72:75], v69 offset:9216
    v_mfma_f32_16x16x32_bf16 v[64:67], v[76:79], v[20:23], v[64:67]
    ds_read_b128 v[76:79], v69 offset:29696
    s_waitcnt lgkmcnt(6)
    v_mfma_f32_16x16x32_bf16 v[56:59], a[120:123], v[20:23], v[56:59]
    v_mfma_f32_16x16x32_bf16 v[48:51], a[124:127], v[20:23], v[48:51]
    s_waitcnt lgkmcnt(4)
    v_mfma_f32_16x16x32_bf16 v[52:55], v[44:47], v[20:23], v[52:55]
    s_waitcnt vmcnt(0)
    v_mfma_f32_16x16x32_bf16 v[60:63], v[40:43], v[24:27], v[60:63]
    s_waitcnt lgkmcnt(2)
    v_mfma_f32_16x16x32_bf16 v[64:67], v[36:39], v[24:27], v[64:67]
    v_mfma_f32_16x16x32_bf16 v[56:59], v[32:35], v[24:27], v[56:59]
    s_waitcnt lgkmcnt(0)
    v_mfma_f32_16x16x32_bf16 v[48:51], v[72:75], v[24:27], v[48:51]
    v_mfma_f32_16x16x32_bf16 v[52:55], v[76:79], v[24:27], v[52:55]
    v_mov_b32 v34, s22
    v_mov_b32 v35, 1
    v_add_u32 v33, s21, v1
    v_mov_b32 v44, 0
    v_mov_b32 v45, 0
    ds_write_b128 v68, v[60:63]
    ds_write_b128 v68, v[64:67] offset:1024
    s_cmp_lg_u32 s43, 1
    s_cbranch_scc1 L_tm_34
    ds_write_b128 v68, v[56:59] offset:2048
L_tm_34:
    ds_write_b32 v34, v35
    v_xor_b32 v34, 8, v34
    s_mov_b32 s79, 0x200000
L_lw_35:
    ds_read_b32 v35, v34 offset:0
    s_sub_u32 s79, s79, 1
    s_cbranch_scc1 L_lw_35_d
    s_waitcnt lgkmcnt(0)
    v_cmp_gt_u32 vcc, 1, v35
    s_cbranch_vccnz L_lw_35
L_lw_35_d:
    ds_read_b128 v[8:11], v33 offset:0
    ds_read_b128 v[12:15], v33 offset:1024
    ds_read_b128 v[16:19], v33 offset:2048
    s_waitcnt lgkmcnt(1)
    v_add_f32 v48, v48, v8
    v_add_f32 v49, v49, v9
    v_add_f32 v50, v50, v10
    v_add_f32 v51, v51, v11
    v_add_f32 v52, v52, v12
    v_add_f32 v53, v53, v13
    v_add_f32 v54, v54, v14
    v_add_f32 v55, v55, v15
    v_cvt_pk_bf16_f32 v2, v48, v49
    v_cvt_pk_bf16_f32 v3, v50, v51
    v_cvt_pk_bf16_f32 v4, v52, v53
    v_cvt_pk_bf16_f32 v5, v54, v55
    s_cmp_eq_u32 s4, 0
    s_cbranch_scc1 L_st_36_s
    buffer_store_dwordx4 v[2:5], v1, s[32:35], s53 offen
L_st_36_b:
    s_cmp_lg_u32 s43, 0
    s_cbranch_scc1 L_not4
    s_waitcnt lgkmcnt(0)
    v_add_f32 v56, v56, v16
    v_add_f32 v57, v57, v17
    v_add_f32 v58, v58, v18
    v_add_f32 v59, v59, v19
    v_cvt_pk_bf16_f32 v6, v56, v57
    v_cvt_pk_bf16_f32 v7, v58, v59
    v_cvt_pk_bf16_f32 v36, v56, v57
    v_cvt_pk_bf16_f32 v37, v58, v59
    v_cvt_pk_bf16_f32 v38, v56, v57
    v_cvt_pk_bf16_f32 v39, v58, v59
    v_dot2c_f32_bf16 v44, s42, v6
    v_dot2c_f32_bf16 v45, v6, v6
    v_dot2c_f32_bf16 v44, s42, v7
    v_dot2c_f32_bf16 v45, v7, v7
    v_permlane16_swap_b32 v36, v38
    v_permlane16_swap_b32 v37, v39
    s_cmp_eq_u32 s4, 0
    s_cbranch_scc1 L_st_37_s
    buffer_store_dwordx4 v[36:39], v31, s[32:35], s54 offen
L_st_37_b:
L_not4:
    v_dot2c_f32_bf16 v44, s42, v2
    v_dot2c_f32_bf16 v45, v2, v2
    v_dot2c_f32_bf16 v44, s42, v3
    v_dot2c_f32_bf16 v45, v3, v3
    v_dot2c_f32_bf16 v44, s42, v4
    v_dot2c_f32_bf16 v45, v4, v4
    v_dot2c_f32_bf16 v44, s42, v5
    v_dot2c_f32_bf16 v45, v5, v5
    s_nop 1
    v_mov_b32 v8, v44
    v_mov_b32 v9, v45
    s_nop 0
    v_permlane32_swap_b32 v44, v8
    v_permlane32_swap_b32 v45, v9
    v_add_f32 v44, v44, v8
    v_add_f32 v45, v45, v9
    v_mov_b32 v8, v44
    v_mov_b32 v9, v45
    s_nop 0
    v_permlane16_swap_b32 v44, v8
    v_permlane16_swap_b32 v45, v9
    v_add_f32 v44, v44, v8
    v_add_f32 v45, v45, v9
    s_mov_b64 exec, 0xffff
    s_cmp_eq_u32 s4, 0
    s_cbranch_scc1 L_st_38_s
    buffer_store_dwordx2 v[44:45], v1, s[32:35], s55 offen
L_st_38_b:
    s_mov_b64 exec, -1
    v_add_u32 v71, s80, v1
    v_and_b32 v47, 48, v0
    v_add_u32 v47, s83, v47
    v_and_b32 v52, 15, v0
    v_lshl_add_u32 v51, v52, 3, s84
    v_lshl_add_u32 v52, v52, 3, s85
    s_cmp_lg_u32 s44, 0
    s_cbranch_scc1 L_tm_39
    v_mov_b32 v25, 159872
    v_subrev_u32 v46, 256, v51
    s_sub_u32 s72, s74, 32
    s_sub_u32 s75, s86, 4096
    v_mov_b32 v24, 1
    s_mov_b64 exec, 1
    ds_add_u32 v25, v24 offset:12
    s_mov_b64 exec, -1
    s_waitcnt vmcnt(0) lgkmcnt(0)
    s_add_u32 s70, s3, 32768
    s_mov_b64 exec, 1
    s_cmp_eq_u32 s4, 0
    s_cbranch_scc1 L_st_40_s
    buffer_store_dwordx2 v[28:29], off, s[32:35], s70
L_st_40_b:
    s_mov_b64 exec, -1
    s_setprio 0
    s_mov_b32 s79, 0x200000
L_lw_41:
    ds_read_b32 v24, v25 offset:8
    s_sub_u32 s79, s79, 1
    s_cbranch_scc1 L_lw_41_d
    s_waitcnt lgkmcnt(0)
    v_cmp_gt_u32 vcc, 4, v24
    s_cbranch_vccnz L_lw_41
L_lw_41_d:
    s_mul_i32 s70, s38, 10240
    s_add_u32 s71, s70, s6
    s_add_u32 m0, s70, 102400
    s_mov_b32 s79, 0x200000
L_poll_42:
    buffer_load_dwordx2 v[26:27], v30, s[32:35], s72 offen sc1
    s_sub_u32 s79, s79, 1
    s_cbranch_scc1 L_poll_42_d
    s_waitcnt vmcnt(0)
    v_cmp_ne_u64 vcc, s[40:41], v[26:27]
    s_cbranch_vccnz L_poll_42
L_poll_42_d:
    buffer_load_dwordx4 v1, s[32:35], s71 offen offset:0 sc1 lds
    buffer_load_dwordx4 v1, s[32:35], s71 offen offset:1024 sc1 lds
    buffer_load_dwordx4 v1, s[32:35], s71 offen offset:2048 sc1 lds
    buffer_load_dwordx4 v1, s[32:35], s71 offen offset:3072 sc1 lds
    buffer_load_dwordx4 v[8:11], v1, s[32:35], s75 offen sc1
    buffer_load_dwordx4 v[12:15], v1, s[32:35], s75 offen offset:1024 sc1
    s_add_u32 m0, m0, 4096
    s_add_u32 s71, s71, 4096
    buffer_load_dwordx4 v1, s[32:35], s71 offen offset:0 sc1 lds
    buffer_load_dwordx4 v1, s[32:35], s71 offen offset:1024 sc1 lds
    buffer_load_dwordx4 v1, s[32:35], s71 offen offset:2048 sc1 lds
    buffer_load_dwordx4 v1, s[32:35], s71 offen offset:3072 sc1 lds
    s_add_u32 m0, m0, 4096
    s_add_u32 s71, s71, 4096
    buffer_load_dwordx4 v1, s[32:35], s71 offen offset:0 sc1 lds
    buffer_load_dwordx4 v1, s[32:35], s71 offen offset:1024 sc1 lds
    s_waitcnt vmcnt(6)
    v_add_f32 v8, v8, v10
    v_add_f32 v9, v9, v11
    v_add_f32 v12, v12, v14
    v_add_f32 v13, v13, v15
    v_add_f32 v8, v8, v12
    v_add_f32 v9, v9, v13
    v_mov_b32 v10, v8
    v_mov_b32 v11, v9
    s_nop 0
    v_permlane32_swap_b32 v8, v10
    v_permlane32_swap_b32 v9, v11
    v_add_f32 v8, v8, v10
    v_add_f32 v9, v9, v11
    v_mov_b32 v10, v8
    v_mov_b32 v11, v9
    s_nop 0
    v_permlane16_swap_b32 v8, v10
    v_permlane16_swap_b32 v9, v11
    v_add_f32 v8, v8, v10
    v_add_f32 v9, v9, v11
    v_mul_f32 v8, 0xbacccccd, v8
    v_mul_f32 v9, 0x3acccccd, v9
    v_fma_f32 v9, -v8, v8, v9
    v_max_f32 v9, 0, v9
    v_add_f32 v9, 0x3727c5ac, v9
    v_rsq_f32 v9, v9
    s_nop 1
    ds_write_b64 v46, v[8:9]
    s_waitcnt vmcnt(0)
L_tm_39:
    s_cmp_lg_u32 s44, 1
    s_cbranch_scc1 L_tm_43
    s_waitcnt vmcnt(0)
    s_add_u32 s70, s3, 32768
    s_mov_b64 exec, 1
    s_cmp_eq_u32 s4, 0
    s_cbranch_scc1 L_st_44_s
    buffer_store_dwordx2 v[28:29], off, s[32:35], s70
L_st_44_b:
    s_mov_b64 exec, -1
L_tm_43:
    s_waitcnt lgkmcnt(0)
    s_barrier
    ds_read_b128 v[72:75], v71 offset:0
    ds_read_b128 v[76:79], v71 offset:1024
    ds_read_b128 a[120:123], v71 offset:2048
    s_setprio 3
    ds_read_b128 a[124:127], v71 offset:3072
    s_waitcnt lgkmcnt(3)
    v_mfma_f32_16x16x32_bf16 v[8:11], a[0:3], v[72:75], 0
    v_mfma_f32_16x16x32_bf16 v[12:15], a[40:43], v[72:75], 0
    v_mfma_f32_16x16x32_bf16 v[16:19], a[80:83], v[72:75], 0
    ds_read_b128 v[56:59], v47 offset:0
    ds_read_b128 v[72:75], v71 offset:4096
    s_waitcnt lgkmcnt(4)
    v_mfma_f32_16x16x32_bf16 v[8:11], a[4:7], v[76:79], v[8:11]
    v_mov_b32 v54, v28
    v_mov_b32 v55, v29
    v_mfma_f32_16x16x32_bf16 v[12:15], a[44:47], v[76:79], v[12:15]
    v_mov_b32 v53, v31
    v_mov_b32 v50, v30
    v_mfma_f32_16x16x32_bf16 v[16:19], a[84:87], v[76:79], v[16:19]
    v_add_u32 v69, s23, v1
    v_add_u32 v68, s81, v1
    ds_read_b128 v[60:63], v47 offset:64
    s_setprio 2
    ds_read_b128 v[76:79], v71 offset:5120
    s_waitcnt lgkmcnt(5)
    v_mfma_f32_16x16x32_bf16 v[8:11], a[8:11], a[120:123], v[8:11]
    v_add_u32 v70, s82, v1
    v_mfma_f32_16x16x32_bf16 v[12:15], a[48:51], a[120:123], v[12:15]
    v_mfma_f32_16x16x32_bf16 v[16:19], a[88:91], a[120:123], v[16:19]
    buffer_load_dwordx2 v[44:45], v50, s[32:35], s74 offen sc1
    ds_read_b128 v[64:67], v47 offset:128
    ds_read_b64 v[48:49], v52
    ds_read_b128 a[120:123], v71 offset:6144
    s_waitcnt lgkmcnt(7)
    v_mfma_f32_16x16x32_bf16 v[8:11], a[12:15], a[124:127], v[8:11]
    v_mfma_f32_16x16x32_bf16 v[12:15], a[52:55], a[124:127], v[12:15]
    v_mfma_f32_16x16x32_bf16 v[16:19], a[92:95], a[124:127], v[16:19]
    s_setprio 1
    ds_read_b128 a[124:127], v71 offset:7168
    s_waitcnt lgkmcnt(6)
    v_mfma_f32_16x16x32_bf16 v[8:11], a[16:19], v[72:75], v[8:11]
    v_mfma_f32_16x16x32_bf16 v[12:15], a[56:59], v[72:75], v[12:15]
    s_waitcnt lgkmcnt(2)
    v_mul_f32 v20, v56, v48
    v_mfma_f32_16x16x32_bf16 v[16:19], a[96:99], v[72:75], v[16:19]
    v_mul_f32 v21, v57, v48
    v_mul_f32 v22, v58, v48
    ds_read_b128 v[72:75], v71 offset:8192
    v_mfma_f32_16x16x32_bf16 v[8:11], a[20:23], v[76:79], v[8:11]
    v_mul_f32 v23, v59, v48
    v_mul_f32 v24, v60, v48
    v_mfma_f32_16x16x32_bf16 v[12:15], a[60:63], v[76:79], v[12:15]
    v_mul_f32 v25, v61, v48
    v_mul_f32 v26, v62, v48
    v_mfma_f32_16x16x32_bf16 v[16:19], a[100:103], v[76:79], v[16:19]
    v_mul_f32 v27, v63, v48
    v_mul_f32 v28, v64, v48
    s_waitcnt vmcnt(0)
    v_cmp_ne_u64 vcc, s[40:41], v[44:45]
    s_cbranch_vccz L_ok_45
    s_mov_b32 s79, 0x200000
L_poll_46:
    buffer_load_dwordx2 v[44:45], v50, s[32:35], s74 offen sc1
    s_sub_u32 s79, s79, 1
    s_cbranch_scc1 L_poll_46_d
    s_waitcnt vmcnt(0)
    v_cmp_ne_u64 vcc, s[40:41], v[44:45]
    s_cbranch_vccnz L_poll_46
L_poll_46_d:
L_ok_45:
    s_add_u32 m0, s77, 0
    s_add_u32 s71, m0, s6
    s_add_u32 s71, s71, 40960
    buffer_load_dwordx4 v1, s[32:35], s71 offen sc1 lds
    s_setprio 0
    ds_read_b128 v[76:79], v71 offset:9216
    s_waitcnt lgkmcnt(3)
    v_mfma_f32_16x16x32_bf16 v[8:11], a[24:27], a[120:123], v[8:11]
    v_mul_f32 v29, v65, v48
    v_mul_f32 v30, v66, v48
    v_mfma_f32_16x16x32_bf16 v[12:15], a[64:67], a[120:123], v[12:15]
    v_mul_f32 v31, v67, v48
    v_mfma_f32_16x16x32_bf16 v[16:19], a[104:107], a[120:123], v[16:19]
    s_add_u32 m0, s77, 8192
    s_add_u32 s71, m0, s6
    s_add_u32 s71, s71, 40960
    buffer_load_dwordx4 v1, s[32:35], s71 offen sc1 lds
    ds_read_b128 a[120:123], v69 offset:0
    s_waitcnt lgkmcnt(3)
    v_mfma_f32_16x16x32_bf16 v[8:11], a[28:31], a[124:127], v[8:11]
    v_mfma_f32_16x16x32_bf16 v[12:15], a[68:71], a[124:127], v[12:15]
    v_mfma_f32_16x16x32_bf16 v[16:19], a[108:111], a[124:127], v[16:19]
    s_setprio 3
    ds_read_b128 a[124:127], v69 offset:1024
    s_waitcnt lgkmcnt(3)
    v_mfma_f32_16x16x32_bf16 v[8:11], a[32:35], v[72:75], v[8:11]
    v_mfma_f32_16x16x32_bf16 v[12:15], a[72:75], v[72:75], v[12:15]
    v_mfma_f32_16x16x32_bf16 v[16:19], a[112:115], v[72:75], v[16:19]
    s_add_u32 m0, s77, 16384
    s_add_u32 s71, m0, s6
    s_add_u32 s71, s71, 40960
    buffer_load_dwordx4 v1, s[32:35], s71 offen sc1 lds
    ds_read_b128 v[72:75], v69 offset:2048
    s_waitcnt lgkmcnt(3)
    v_mfma_f32_16x16x32_bf16 v[8:11], a[36:39], v[76:79], v[8:11]
    v_mfma_f32_16x16x32_bf16 v[12:15], a[76:79], v[76:79], v[12:15]
    v_mfma_f32_16x16x32_bf16 v[16:19], a[116:119], v[76:79], v[16:19]
    s_add_u32 m0, s77, 24576
    s_add_u32 s71, m0, s6
    s_add_u32 s71, s71, 40960
    buffer_load_dwordx4 v1, s[32:35], s71 offen sc1 lds
    s_setprio 2
    ds_read_b128 v[76:79], v69 offset:3072
    s_waitcnt lgkmcnt(3)
    v_mfma_f32_16x16x32_bf16 v[20:23], a[0:3], a[120:123], v[20:23]
    v_mfma_f32_16x16x32_bf16 v[24:27], a[40:43], a[120:123], v[24:27]
    v_mfma_f32_16x16x32_bf16 v[28:31], a[80:83], a[120:123], v[28:31]
    buffer_load_dwordx4 v[32:35], v1, s[32:35], s86 offen sc1
    buffer_load_dwordx4 v[36:39], v1, s[32:35], s86 offen offset:1024 sc1
    ds_read_b128 a[120:123], v69 offset:4096
    s_waitcnt lgkmcnt(3)
    v_mfma_f32_16x16x32_bf16 v[20:23], a[4:7], a[124:127], v[20:23]
    v_mfma_f32_16x16x32_bf16 v[24:27], a[44:47], a[124:127], v[24:27]
    v_mfma_f32_16x16x32_bf16 v[28:31], a[84:87], a[124:127], v[28:31]
    ds_write_b128 v68, v[8:11] offset:0
    s_setprio 1
    ds_read_b128 a[124:127], v69 offset:5120
    s_waitcnt lgkmcnt(4)
    v_mfma_f32_16x16x32_bf16 v[20:23], a[8:11], v[72:75], v[20:23]
    v_mfma_f32_16x16x32_bf16 v[24:27], a[48:51], v[72:75], v[24:27]
    v_mfma_f32_16x16x32_bf16 v[28:31], a[88:91], v[72:75], v[28:31]
    s_add_u32 m0, s77, 32768
    s_add_u32 s71, m0, s6
    s_add_u32 s71, s71, 40960
    buffer_load_dwordx4 v1, s[32:35], s71 offen sc1 lds
    ds_read_b128 v[72:75], v69 offset:6144
    s_waitcnt lgkmcnt(4)
    v_mfma_f32_16x16x32_bf16 v[20:23], a[12:15], v[76:79], v[20:23]
    v_mfma_f32_16x16x32_bf16 v[24:27], a[52:55], v[76:79], v[24:27]
    v_mfma_f32_16x16x32_bf16 v[28:31], a[92:95], v[76:79], v[28:31]
    s_add_u32 m0, s77, 65536
    s_add_u32 s70, s7, 100352
    buffer_load_dwordx4 v1, s[32:35], s70 offen sc1 lds
    s_setprio 0
    ds_read_b128 v[76:79], v69 offset:7168
    s_waitcnt lgkmcnt(4)
    v_mfma_f32_16x16x32_bf16 v[20:23], a[16:19], a[120:123], v[20:23]
    v_mfma_f32_16x16x32_bf16 v[24:27], a[56:59], a[120:123], v[24:27]
    v_mfma_f32_16x16x32_bf16 v[28:31], a[96:99], a[120:123], v[28:31]
    s_add_u32 m0, s77, 73728
    s_add_u32 s70, s7, 149504
    buffer_load_dwordx4 v1, s[32:35], s70 offen sc1 lds
    ds_write_b128 v68, v[12:15] offset:1024
    ds_read_b128 a[120:123], v69 offset:8192
    s_waitcnt lgkmcnt(4)
    v_mfma_f32_16x16x32_bf16 v[20:23], a[20:23], a[124:127], v[20:23]
    s_waitcnt vmcnt(3)
    v_add_f32 v32, v32, v34
    v_mfma_f32_16x16x32_bf16 v[24:27], a[60:63], a[124:127], v[24:27]
    v_add_f32 v33, v33, v35
    v_add_f32 v36, v36, v38
    v_mfma_f32_16x16x32_bf16 v[28:31], a[100:103], a[124:127], v[28:31]
    v_add_f32 v37, v37, v39
    v_add_f32 v32, v32, v36
    s_setprio 3
    ds_read_b128 a[124:127], v69 offset:9216
    s_waitcnt lgkmcnt(4)
    v_mfma_f32_16x16x32_bf16 v[20:23], a[24:27], v[72:75], v[20:23]
    v_add_f32 v33, v33, v37
    v_mov_b32 v34, v32
    v_mfma_f32_16x16x32_bf16 v[24:27], a[64:67], v[72:75], v[24:27]
    v_mov_b32 v35, v33
    v_permlane32_swap_b32 v32, v34
    v_mfma_f32_16x16x32_bf16 v[28:31], a[104:107], v[72:75], v[28:31]
    v_permlane32_swap_b32 v33, v35
    v_add_f32 v32, v32, v34
    s_add_u32 m0, s77, 81920
    s_add_u32 s70, s7, 198656
    buffer_load_dwordx4 v1, s[32:35], s70 offen sc1 lds
    s_waitcnt lgkmcnt(3)
    v_mfma_f32_16x16x32_bf16 v[20:23], a[28:31], v[76:79], v[20:23]
    v_add_f32 v33, v33, v35
    v_mov_b32 v34, v32
    v_mfma_f32_16x16x32_bf16 v[24:27], a[68:71], v[76:79], v[24:27]
    v_mov_b32 v35, v33
    v_permlane16_swap_b32 v32, v34
    v_mfma_f32_16x16x32_bf16 v[28:31], a[108:111], v[76:79], v[28:31]
    v_permlane16_swap_b32 v33, v35
    v_add_f32 v32, v32, v34
    s_add_u32 m0, s77, 90112
    s_add_u32 s70, s7, 3072
    buffer_load_dwordx4 v1, s[32:35], s70 offen sc1 lds
    ds_write_b128 v68, v[16:19] offset:2048
    s_setprio 2
    s_waitcnt lgkmcnt(2)
    v_mfma_f32_16x16x32_bf16 v[20:23], a[32:35], a[120:123], v[20:23]
    v_add_f32 v33, v33, v35
    v_mul_f32 v32, 0xbacccccd, v32
    v_mfma_f32_16x16x32_bf16 v[24:27], a[72:75], a[120:123], v[24:27]
    v_mul_f32 v33, 0x3acccccd, v33
    v_fma_f32 v33, -v32, v32, v33
    v_mfma_f32_16x16x32_bf16 v[28:31], a[112:115], a[120:123], v[28:31]
    v_max_f32 v33, 0, v33
    v_add_f32 v33, 0x3727c5ac, v33
    s_waitcnt lgkmcnt(1)
    v_mfma_f32_16x16x32_bf16 v[20:23], a[36:39], a[124:127], v[20:23]
    v_rsq_f32 v33, v33
    s_nop 1
    v_mfma_f32_16x16x32_bf16 v[24:27], a[76:79], a[124:127], v[24:27]
    ds_write_b64 v51, v[32:33]
    v_mfma_f32_16x16x32_bf16 v[28:31], a[116:119], a[124:127], v[28:31]
    s_add_u32 m0, s77, 151552
    s_add_u32 s70, s7, 101376
    buffer_load_dwordx4 v1, s[32:35], s70 offen sc1 lds
    s_add_u32 m0, s77, 143360
    s_add_u32 s70, s7, 52224
    buffer_load_dwordx4 v1, s[32:35], s70 offen sc1 lds
    v_subrev_u32 v69, 102400, v69
    v_subrev_u32 v71, 102400, v71
    s_waitcnt vmcnt(6) lgkmcnt(0)
    s_barrier
    ds_read_b128 v[32:35], v70 offset:0
    ds_read_b128 v[36:39], v70 offset:1024
    ds_read_b128 v[40:43], v70 offset:2048
    ds_read_b64 v[50:51], v52 offset:256
    ds_read_b128 v[72:75], v71 offset:0
    ds_read_b128 v[76:79], v71 offset:1024
    ds_read_b128 a[120:123], v71 offset:2048
    s_setprio 3
    ds_read_b128 a[124:127], v71 offset:3072
    s_waitcnt lgkmcnt(3)
    v_mfma_f32_16x16x32_bf16 v[8:11], a[0:3], v[72:75], 0
    v_mfma_f32_16x16x32_bf16 v[12:15], a[40:43], v[72:75], 0
    v_mfma_f32_16x16x32_bf16 v[16:19], a[80:83], v[72:75], 0
    s_add_u32 m0, s77, 102400
    s_add_u32 s70, s7, 150528
    buffer_load_dwordx4 v1, s[32:35], s70 offen sc1 lds
    ds_read_b128 v[72:75], v71 offset:4096
    s_waitcnt lgkmcnt(3)
    v_mfma_f32_16x16x32_bf16 v[8:11], a[4:7], v[76:79], v[8:11]
    v_add_f32 v20, v20, v32
    v_add_f32 v21, v21, v33
    v_add_f32 v22, v22, v34
    v_mfma_f32_16x16x32_bf16 v[12:15], a[44:47], v[76:79], v[12:15]
    v_add_f32 v23, v23, v35
    v_add_f32 v24, v24, v36
    v_add_f32 v25, v25, v37
    v_mfma_f32_16x16x32_bf16 v[16:19], a[84:87], v[76:79], v[16:19]
    v_add_f32 v26, v26, v38
    v_add_f32 v27, v27, v39
    v_add_f32 v28, v28, v40
    s_add_u32 m0, s77, 110592
    s_add_u32 s70, s7, 199680
    buffer_load_dwordx4 v1, s[32:35], s70 offen sc1 lds
    s_setprio 2
    ds_read_b128 v[76:79], v69 offset:0
    s_waitcnt lgkmcnt(3)
    v_mfma_f32_16x16x32_bf16 v[8:11], a[8:11], a[120:123], v[8:11]
    v_add_f32 v29, v29, v41
    v_add_f32 v30, v30, v42
    v_add_f32 v31, v31, v43
    v_mfma_f32_16x16x32_bf16 v[12:15], a[48:51], a[120:123], v[12:15]
    v_mul_f32 v20, v20, v49
    v_mul_f32 v21, v21, v49
    v_mul_f32 v22, v22, v49
    v_mfma_f32_16x16x32_bf16 v[16:19], a[88:91], a[120:123], v[16:19]
    v_mul_f32 v23, v23, v49
    v_mul_f32 v24, v24, v49
    v_mul_f32 v25, v25, v49
    ds_read_b128 a[120:123], v71 offset:5120
    s_waitcnt lgkmcnt(3)
    v_mfma_f32_16x16x32_bf16 v[8:11], a[12:15], a[124:127], v[8:11]
    v_mul_f32 v26, v26, v49
    v_mul_f32 v27, v27, v49
    v_mul_f32 v28, v28, v49
    v_mfma_f32_16x16x32_bf16 v[12:15], a[52:55], a[124:127], v[12:15]
    v_mul_f32 v29, v29, v49
    v_mul_f32 v30, v30, v49
    v_mul_f32 v31, v31, v49
    v_mfma_f32_16x16x32_bf16 v[16:19], a[92:95], a[124:127], v[16:19]
    v_cvt_pk_bf16_f32 v44, v20, v21
    v_cvt_pk_bf16_f32 v45, v22, v23
    v_cvt_pk_bf16_f32 v46, v24, v25
    s_add_u32 m0, s77, 118784
    s_add_u32 s70, s7, 4096
    buffer_load_dwordx4 v1, s[32:35], s70 offen sc1 lds
    s_setprio 1
    ds_read_b128 a[124:127], v69 offset:1024
    s_waitcnt lgkmcnt(3)
    v_mfma_f32_16x16x32_bf16 v[8:11], a[16:19], v[72:75], v[8:11]
    v_cvt_pk_bf16_f32 v47, v26, v27
    v_cvt_pk_bf16_f32 v20, v28, v29
    v_cvt_pk_bf16_f32 v21, v30, v31
    v_mfma_f32_16x16x32_bf16 v[12:15], a[56:59], v[72:75], v[12:15]
    v_pk_max_i16 v44, v44, 0
    v_pk_max_i16 v45, v45, 0
    v_pk_max_i16 v46, v46, 0
    v_mfma_f32_16x16x32_bf16 v[16:19], a[96:99], v[72:75], v[16:19]
    v_pk_max_i16 v47, v47, 0
    v_pk_max_i16 v22, v20, 0
    v_pk_max_i16 v23, v21, 0
    ds_read_b128 v[72:75], v71 offset:6144
    s_waitcnt lgkmcnt(3)
    v_mfma_f32_16x16x32_bf16 v[32:35], a[0:3], v[76:79], 0
    v_pk_max_i16 v20, v20, 0
    v_pk_max_i16 v21, v21, 0
    s_cmp_eq_u32 s4, 0
    s_cbranch_scc1 L_st_47_s
    buffer_store_dwordx4 v[44:47], v1, s[32:35], s64 offen
L_st_47_b:
    v_mfma_f32_16x16x32_bf16 v[36:39], a[40:43], v[76:79], 0
    v_permlane16_swap_b32 v20, v22
    v_permlane16_swap_b32 v21, v23
    s_cmp_eq_u32 s4, 0
    s_cbranch_scc1 L_st_48_s
    buffer_store_dwordx4 v[20:23], v53, s[32:35], s65 offen
L_st_48_b:
    v_mfma_f32_16x16x32_bf16 v[40:43], a[80:83], v[76:79], 0
    s_add_u32 s71, s77, 65536
    v_add_u32 v24, s71, v1
    v_add_u32 v25, 36864, v24
    s_setprio 0
    ds_read_b128 v[76:79], v69 offset:2048
    s_waitcnt lgkmcnt(3)
    v_mfma_f32_16x16x32_bf16 v[8:11], a[20:23], a[120:123], v[8:11]
    v_and_b32 v52, 7, v0
    v_lshlrev_b32 v52, 3, v52
    s_lshl_b32 s71, s38, 7
    v_mfma_f32_16x16x32_bf16 v[12:15], a[60:63], a[120:123], v[12:15]
    s_add_u32 s74, s73, s71
    s_add_u32 s74, s74, 131072
    v_mfma_f32_16x16x32_bf16 v[16:19], a[100:103], a[120:123], v[16:19]
    s_add_u32 m0, s77, 126976
    s_add_u32 s70, s7, 53248
    buffer_load_dwordx4 v1, s[32:35], s70 offen sc1 lds
    ds_read_b128 a[120:123], v71 offset:7168
    s_waitcnt lgkmcnt(3)
    v_mfma_f32_16x16x32_bf16 v[32:35], a[4:7], a[124:127], v[32:35]
    v_mfma_f32_16x16x32_bf16 v[36:39], a[44:47], a[124:127], v[36:39]
    v_mfma_f32_16x16x32_bf16 v[40:43], a[84:87], a[124:127], v[40:43]
    s_add_u32 m0, s77, 135168
    s_add_u32 s70, s7, 102400
    buffer_load_dwordx4 v1, s[32:35], s70 offen sc1 lds
    s_setprio 3
    ds_read_b128 a[124:127], v69 offset:3072
    s_waitcnt lgkmcnt(3)
    v_mfma_f32_16x16x32_bf16 v[8:11], a[24:27], v[72:75], v[8:11]
    v_mfma_f32_16x16x32_bf16 v[12:15], a[64:67], v[72:75], v[12:15]
    v_mfma_f32_16x16x32_bf16 v[16:19], a[104:107], v[72:75], v[16:19]
    ds_read_b128 v[72:75], v71 offset:8192
    s_waitcnt lgkmcnt(3)
    v_mfma_f32_16x16x32_bf16 v[32:35], a[8:11], v[76:79], v[32:35]
    v_mfma_f32_16x16x32_bf16 v[36:39], a[48:51], v[76:79], v[36:39]
    v_mfma_f32_16x16x32_bf16 v[40:43], a[88:91], v[76:79], v[40:43]
    s_add_u32 s70, s7, 151552
    buffer_load_dwordx4 a[0:3], v1, s[32:35], s70 offen offset:0 sc1
    s_barrier
    s_setprio 2
    ds_read_b128 v[76:79], v69 offset:4096
    s_waitcnt lgkmcnt(3)
    v_mfma_f32_16x16x32_bf16 v[8:11], a[28:31], a[120:123], v[8:11]
    v_mfma_f32_16x16x32_bf16 v[12:15], a[68:71], a[120:123], v[12:15]
    v_mfma_f32_16x16x32_bf16 v[16:19], a[108:111], a[120:123], v[16:19]
    s_waitcnt vmcnt(3)
    s_add_u32 s70, s3, 65536
    s_mov_b64 exec, 1
    s_cmp_eq_u32 s4, 0
    s_cbranch_scc1 L_st_49_s
    buffer_store_dwordx2 v[54:55], off, s[32:35], s70
L_st_49_b:
    s_mov_b64 exec, -1
    s_add_u32 s70, s7, 200704
    buffer_load_dwordx4 a[40:43], v1, s[32:35], s70 offen offset:0 sc1
    ds_read_b128 a[84:87], v24 offset:0
    ds_read_b128 a[8:11], v24 offset:8192
    ds_read_b128 a[120:123], v71 offset:9216
    s_waitcnt lgkmcnt(5)
    v_mfma_f32_16x16x32_bf16 v[32:35], a[12:15], a[124:127], v[32:35]
    v_mfma_f32_16x16x32_bf16 v[36:39], a[52:55], a[124:127], v[36:39]
    v_mfma_f32_16x16x32_bf16 v[40:43], a[92:95], a[124:127], v[40:43]
    ds_read_b128 a[48:51], v24 offset:16384
    ds_read_b128 a[88:91], v24 offset:24576
    s_setprio 1
    ds_read_b128 a[124:127], v69 offset:5120
    s_waitcnt lgkmcnt(7)
    v_mfma_f32_16x16x32_bf16 v[8:11], a[32:35], v[72:75], v[8:11]
    v_mfma_f32_16x16x32_bf16 v[12:15], a[72:75], v[72:75], v[12:15]
    v_mfma_f32_16x16x32_bf16 v[16:19], a[112:115], v[72:75], v[16:19]
    s_add_u32 s70, s7, 4096
    buffer_load_dwordx4 a[80:83], v1, s[32:35], s70 offen offset:1024 sc1
    ds_read_b128 a[12:15], v25 offset:40960
    ds_read_b128 a[52:55], v25 offset:49152
    ds_read_b128 v[72:75], v69 offset:6144
    s_waitcnt lgkmcnt(9)
    v_mfma_f32_16x16x32_bf16 v[32:35], a[16:19], v[76:79], v[32:35]
    v_mfma_f32_16x16x32_bf16 v[36:39], a[56:59], v[76:79], v[36:39]
    v_mfma_f32_16x16x32_bf16 v[40:43], a[96:99], v[76:79], v[40:43]
    s_add_u32 s70, s7, 53248
    buffer_load_dwordx4 a[4:7], v1, s[32:35], s70 offen offset:1024 sc1
    s_waitcnt vmcnt(5)
    ds_read_b128 a[92:95], v25 offset:0
    ds_read_b128 a[16:19], v25 offset:8192
    s_setprio 0
    ds_read_b128 v[76:79], v69 offset:7168
    s_waitcnt lgkmcnt(9)
    v_mfma_f32_16x16x32_bf16 v[8:11], a[36:39], a[120:123], v[8:11]
    v_mfma_f32_16x16x32_bf16 v[12:15], a[76:79], a[120:123], v[12:15]
    v_mfma_f32_16x16x32_bf16 v[16:19], a[116:119], a[120:123], v[16:19]
    ds_read_b128 a[56:59], v25 offset:16384
    ds_read_b128 a[96:99], v25 offset:24576
    ds_read_b128 a[120:123], v69 offset:8192
    s_waitcnt lgkmcnt(9)
    v_mfma_f32_16x16x32_bf16 v[32:35], a[20:23], a[124:127], v[32:35]
    v_mfma_f32_16x16x32_bf16 v[36:39], a[60:63], a[124:127], v[36:39]
    v_mfma_f32_16x16x32_bf16 v[40:43], a[100:103], a[124:127], v[40:43]
    ds_write_b128 v68, v[8:11] offset:0
    s_add_u32 s70, s7, 102400
    buffer_load_dwordx4 a[44:47], v1, s[32:35], s70 offen offset:1024 sc1
    ds_read_b128 a[20:23], v25 offset:32768
    s_setprio 3
    ds_read_b128 a[124:127], v69 offset:9216
    s_waitcnt lgkmcnt(9)
    v_mfma_f32_16x16x32_bf16 v[32:35], a[24:27], v[72:75], v[32:35]
    v_mfma_f32_16x16x32_bf16 v[36:39], a[64:67], v[72:75], v[36:39]
    v_mfma_f32_16x16x32_bf16 v[40:43], a[104:107], v[72:75], v[40:43]
    buffer_load_dwordx2 v[26:27], v52, s[32:35], s74 offen sc1
    s_waitcnt lgkmcnt(6)
    v_mfma_f32_16x16x32_bf16 v[32:35], a[28:31], v[76:79], v[32:35]
    v_mfma_f32_16x16x32_bf16 v[36:39], a[68:71], v[76:79], v[36:39]
    v_mfma_f32_16x16x32_bf16 v[40:43], a[108:111], v[76:79], v[40:43]
    ds_write_b128 v68, v[12:15] offset:1024
    s_add_u32 s70, s7, 151552
    buffer_load_dwordx4 a[60:63], v1, s[32:35], s70 offen offset:1024 sc1
    s_setprio 2
    s_waitcnt lgkmcnt(4)
    v_mfma_f32_16x16x32_bf16 v[32:35], a[32:35], a[120:123], v[32:35]
    v_mfma_f32_16x16x32_bf16 v[36:39], a[72:75], a[120:123], v[36:39]
    v_mfma_f32_16x16x32_bf16 v[40:43], a[112:115], a[120:123], v[40:43]
    s_add_u32 s70, s7, 200704
    buffer_load_dwordx4 a[100:103], v1, s[32:35], s70 offen offset:1024 sc1
    s_waitcnt lgkmcnt(1)
    v_mfma_f32_16x16x32_bf16 v[32:35], a[36:39], a[124:127], v[32:35]
    v_mfma_f32_16x16x32_bf16 v[36:39], a[76:79], a[124:127], v[36:39]
    v_mfma_f32_16x16x32_bf16 v[40:43], a[116:119], a[124:127], v[40:43]
    ds_write_b128 v68, v[16:19] offset:2048
    s_waitcnt vmcnt(2)
    v_cmp_ne_u64 vcc, s[40:41], v[26:27]
    s_cbranch_vccz L_ok_50
    s_mov_b32 s79, 0x200000
L_poll_51:
    buffer_load_dwordx2 v[26:27], v52, s[32:35], s74 offen sc1
    s_sub_u32 s79, s79, 1
    s_cbranch_scc1 L_poll_51_d
    s_waitcnt vmcnt(0)
    v_cmp_ne_u64 vcc, s[40:41], v[26:27]
    s_cbranch_vccnz L_poll_51
L_poll_51_d:
L_ok_50:
    s_add_u32 s75, s66, 0
    buffer_load_dwordx4 a[24:27], v1, s[32:35], s75 offen offset:0 sc1
    buffer_load_dwordx4 a[64:67], v1, s[32:35], s75 offen offset:1024 sc1
    s_waitcnt lgkmcnt(0)
    s_barrier
    ds_read_b128 v[20:23], v70 offset:0
    ds_read_b128 v[24:27], v70 offset:1024
    ds_read_b128 v[28:31], v70 offset:2048
    s_setprio 3
    v_add_u32 v68, s77, v1
    s_add_u32 s74, s74, 0x8000
    buffer_load_dwordx4 a[104:107], v1, s[32:35], s75 offen offset:2048 sc1
    buffer_load_dwordx4 a[28:31], v1, s[32:35], s75 offen offset:3072 sc1
    v_pk_fma_f32 v[32:33], v[56:57], v[50:51], v[32:33] op_sel_hi:[1,0,1]
    v_pk_fma_f32 v[34:35], v[58:59], v[50:51], v[34:35] op_sel_hi:[1,0,1]
    v_pk_fma_f32 v[36:37], v[60:61], v[50:51], v[36:37] op_sel_hi:[1,0,1]
    v_pk_fma_f32 v[38:39], v[62:63], v[50:51], v[38:39] op_sel_hi:[1,0,1]
    v_pk_fma_f32 v[40:41], v[64:65], v[50:51], v[40:41] op_sel_hi:[1,0,1]
    v_pk_fma_f32 v[42:43], v[66:67], v[50:51], v[42:43] op_sel_hi:[1,0,1]
    s_waitcnt lgkmcnt(0)
    v_pk_add_f32 v[32:33], v[32:33], v[20:21]
    v_pk_add_f32 v[34:35], v[34:35], v[22:23]
    v_pk_add_f32 v[36:37], v[36:37], v[24:25]
    v_pk_add_f32 v[38:39], v[38:39], v[26:27]
    v_pk_add_f32 v[40:41], v[40:41], v[28:29]
    v_pk_add_f32 v[42:43], v[42:43], v[30:31]
    v_pk_mul_f32 v[32:33], v[32:33], v[50:51] op_sel:[0,1]
    v_pk_mul_f32 v[34:35], v[34:35], v[50:51] op_sel:[0,1]
    v_pk_mul_f32 v[36:37], v[36:37], v[50:51] op_sel:[0,1]
    v_pk_mul_f32 v[38:39], v[38:39], v[50:51] op_sel:[0,1]
    v_pk_mul_f32 v[40:41], v[40:41], v[50:51] op_sel:[0,1]
    v_pk_mul_f32 v[42:43], v[42:43], v[50:51] op_sel:[0,1]
    v_cvt_pk_bf16_f32 v44, v32, v33
    v_cvt_pk_bf16_f32 v45, v34, v35
    v_cvt_pk_bf16_f32 v46, v36, v37
    v_cvt_pk_bf16_f32 v47, v38, v39
    v_cvt_pk_bf16_f32 v32, v40, v41
    v_cvt_pk_bf16_f32 v33, v42, v43
    v_pk_max_i16 v44, v44, 0
    v_pk_max_i16 v45, v45, 0
    v_pk_max_i16 v46, v46, 0
    v_pk_max_i16 v47, v47, 0
    v_pk_max_i16 v34, v32, 0
    v_pk_max_i16 v35, v33, 0
    v_pk_max_i16 v32, v32, 0
    v_pk_max_i16 v33, v33, 0
    s_add_u32 s64, s64, 98304
    s_add_u32 s65, s65, 98304
    s_cmp_eq_u32 s4, 0
    s_cbranch_scc1 L_st_52_s
    buffer_store_dwordx4 v[44:47], v1, s[32:35], s64 offen
L_st_52_b:
    v_permlane16_swap_b32 v32, v34
    v_permlane16_swap_b32 v33, v35
    s_cmp_eq_u32 s4, 0
    s_cbranch_scc1 L_st_53_s
    buffer_store_dwordx4 v[32:35], v53, s[32:35], s65 offen
L_st_53_b:
    s_setprio 2
    s_waitcnt vmcnt(5)
    v_mfma_f32_16x16x32_bf16 v[8:11], v[80:83], a[24:27], 0
    v_mfma_f32_16x16x32_bf16 v[12:15], v[84:87], a[24:27], 0
    v_mfma_f32_16x16x32_bf16 v[16:19], v[88:91], a[24:27], 0
    v_mfma_f32_16x16x32_bf16 v[20:23], v[92:95], a[24:27], 0
    v_mfma_f32_16x16x32_bf16 v[24:27], v[96:99], a[24:27], 0
    s_add_u32 s75, s66, 4096
    buffer_load_dwordx4 a[68:71], v1, s[32:35], s75 offen offset:0 sc1
    s_waitcnt vmcnt(5)
    v_mfma_f32_16x16x32_bf16 v[8:11], v[100:103], a[64:67], v[8:11]
    v_mfma_f32_16x16x32_bf16 v[12:15], v[104:107], a[64:67], v[12:15]
    v_mfma_f32_16x16x32_bf16 v[16:19], v[108:111], a[64:67], v[16:19]
    v_mfma_f32_16x16x32_bf16 v[20:23], v[112:115], a[64:67], v[20:23]
    v_mfma_f32_16x16x32_bf16 v[24:27], v[116:119], a[64:67], v[24:27]
    buffer_load_dwordx4 a[108:111], v1, s[32:35], s75 offen offset:1024 sc1
    s_setprio 1
    s_waitcnt vmcnt(5)
    v_mfma_f32_16x16x32_bf16 v[8:11], v[120:123], a[104:107], v[8:11]
    v_mfma_f32_16x16x32_bf16 v[12:15], v[124:127], a[104:107], v[12:15]
    v_mfma_f32_16x16x32_bf16 v[16:19], a[84:87], a[104:107], v[16:19]
    v_mfma_f32_16x16x32_bf16 v[20:23], a[8:11], a[104:107], v[20:23]
    v_mfma_f32_16x16x32_bf16 v[24:27], a[48:51], a[104:107], v[24:27]
    s_add_u32 s75, s66, 49152
    buffer_load_dwordx4 a[32:35], v1, s[32:35], s75 offen offset:0 sc1
    s_waitcnt vmcnt(5)
    v_mfma_f32_16x16x32_bf16 v[8:11], a[88:91], a[28:31], v[8:11]
    v_mfma_f32_16x16x32_bf16 v[12:15], a[12:15], a[28:31], v[12:15]
    v_mfma_f32_16x16x32_bf16 v[16:19], a[52:55], a[28:31], v[16:19]
    v_mfma_f32_16x16x32_bf16 v[20:23], a[92:95], a[28:31], v[20:23]
    v_mfma_f32_16x16x32_bf16 v[24:27], a[16:19], a[28:31], v[24:27]
    s_waitcnt vmcnt(3)
    s_add_u32 s70, s3, 98304
    s_mov_b64 exec, 1
    s_cmp_eq_u32 s4, 0
    s_cbranch_scc1 L_st_54_s
    buffer_store_dwordx2 v[54:55], off, s[32:35], s70
L_st_54_b:
    s_mov_b64 exec, -1
    buffer_load_dwordx4 a[72:75], v1, s[32:35], s75 offen offset:1024 sc1
    s_setprio 0
    s_waitcnt vmcnt(4)
    v_mfma_f32_16x16x32_bf16 v[8:11], a[56:59], a[68:71], v[8:11]
    v_mfma_f32_16x16x32_bf16 v[12:15], a[96:99], a[68:71], v[12:15]
    v_mfma_f32_16x16x32_bf16 v[16:19], a[20:23], a[68:71], v[16:19]
    v_mfma_f32_16x16x32_bf16 v[20:23], a[0:3], a[68:71], v[20:23]
    v_mfma_f32_16x16x32_bf16 v[24:27], a[40:43], a[68:71], v[24:27]
    buffer_load_dwordx4 a[112:115], v1, s[32:35], s75 offen offset:2048 sc1
    s_waitcnt vmcnt(4)
    v_mfma_f32_16x16x32_bf16 v[8:11], a[80:83], a[108:111], v[8:11]
    v_mfma_f32_16x16x32_bf16 v[12:15], a[4:7], a[108:111], v[12:15]
    v_mfma_f32_16x16x32_bf16 v[16:19], a[44:47], a[108:111], v[16:19]
    v_mfma_f32_16x16x32_bf16 v[20:23], a[60:63], a[108:111], v[20:23]
    v_mfma_f32_16x16x32_bf16 v[24:27], a[100:103], a[108:111], v[24:27]
    buffer_load_dwordx4 a[36:39], v1, s[32:35], s75 offen offset:3072 sc1
    s_setprio 3
    s_waitcnt vmcnt(4)
    v_mfma_f32_16x16x32_bf16 v[28:31], v[80:83], a[32:35], 0
    v_mfma_f32_16x16x32_bf16 v[32:35], v[84:87], a[32:35], 0
    v_mfma_f32_16x16x32_bf16 v[36:39], v[88:91], a[32:35], 0
    v_mfma_f32_16x16x32_bf16 v[40:43], v[92:95], a[32:35], 0
    v_mfma_f32_16x16x32_bf16 v[44:47], v[96:99], a[32:35], 0
    s_add_u32 s75, s66, 53248
    buffer_load_dwordx4 a[76:79], v1, s[32:35], s75 offen offset:0 sc1
    s_waitcnt vmcnt(3)
    v_mfma_f32_16x16x32_bf16 v[28:31], v[100:103], a[72:75], v[28:31]
    v_mfma_f32_16x16x32_bf16 v[32:35], v[104:107], a[72:75], v[32:35]
    v_mfma_f32_16x16x32_bf16 v[36:39], v[108:111], a[72:75], v[36:39]
    ds_write_b128 v68, v[8:11] offset:0
    v_mfma_f32_16x16x32_bf16 v[40:43], v[112:115], a[72:75], v[40:43]
    v_mfma_f32_16x16x32_bf16 v[44:47], v[116:119], a[72:75], v[44:47]
    buffer_load_dwordx2 v[48:49], v52, s[32:35], s74 offen sc1
    buffer_load_dwordx4 a[116:119], v1, s[32:35], s75 offen offset:1024 sc1
    s_setprio 2
    s_waitcnt vmcnt(4)
    v_mfma_f32_16x16x32_bf16 v[28:31], v[120:123], a[112:115], v[28:31]
    v_mfma_f32_16x16x32_bf16 v[32:35], v[124:127], a[112:115], v[32:35]
    v_mfma_f32_16x16x32_bf16 v[36:39], a[84:87], a[112:115], v[36:39]
    ds_write_b128 v68, v[12:15] offset:8192
    v_mfma_f32_16x16x32_bf16 v[40:43], a[8:11], a[112:115], v[40:43]
    v_mfma_f32_16x16x32_bf16 v[44:47], a[48:51], a[112:115], v[44:47]
    s_waitcnt vmcnt(3)
    v_mfma_f32_16x16x32_bf16 v[28:31], a[88:91], a[36:39], v[28:31]
    v_mfma_f32_16x16x32_bf16 v[32:35], a[12:15], a[36:39], v[32:35]
    v_mfma_f32_16x16x32_bf16 v[36:39], a[52:55], a[36:39], v[36:39]
    ds_write_b128 v68, v[16:19] offset:16384
    v_mfma_f32_16x16x32_bf16 v[40:43], a[92:95], a[36:39], v[40:43]
    v_mfma_f32_16x16x32_bf16 v[44:47], a[16:19], a[36:39], v[44:47]
    s_waitcnt vmcnt(1)
    v_cmp_ne_u64 vcc, s[40:41], v[48:49]
    s_cbranch_vccz L_ok_55
    s_mov_b32 s79, 0x200000
L_poll_56:
    buffer_load_dwordx2 v[48:49], v52, s[32:35], s74 offen sc1
    s_sub_u32 s79, s79, 1
    s_cbranch_scc1 L_poll_56_d
    s_waitcnt vmcnt(0)
    v_cmp_ne_u64 vcc, s[40:41], v[48:49]
    s_cbranch_vccnz L_poll_56
L_poll_56_d:
L_ok_55:
    s_add_u32 s75, s66, 98304
    buffer_load_dwordx4 a[24:27], v1, s[32:35], s75 offen offset:0 sc1
    buffer_load_dwordx4 a[64:67], v1, s[32:35], s75 offen offset:1024 sc1
    s_setprio 1
    s_waitcnt vmcnt(4)
    s_barrier
    v_mfma_f32_16x16x32_bf16 v[28:31], a[56:59], a[76:79], v[28:31]
    v_mfma_f32_16x16x32_bf16 v[32:35], a[96:99], a[76:79], v[32:35]
    v_mfma_f32_16x16x32_bf16 v[36:39], a[20:23], a[76:79], v[36:39]
    ds_write_b128 v68, v[20:23] offset:24576
    v_mfma_f32_16x16x32_bf16 v[40:43], a[0:3], a[76:79], v[40:43]
    v_mfma_f32_16x16x32_bf16 v[44:47], a[40:43], a[76:79], v[44:47]
    buffer_load_dwordx4 a[104:107], v1, s[32:35], s75 offen offset:2048 sc1
    s_waitcnt vmcnt(3)
    v_mfma_f32_16x16x32_bf16 v[28:31], a[80:83], a[116:119], v[28:31]
    v_mfma_f32_16x16x32_bf16 v[32:35], a[4:7], a[116:119], v[32:35]
    v_mfma_f32_16x16x32_bf16 v[36:39], a[44:47], a[116:119], v[36:39]
    ds_write_b128 v68, v[24:27] offset:32768
    v_add_u32 v68, 40960, v68
    v_mfma_f32_16x16x32_bf16 v[40:43], a[60:63], a[116:119], v[40:43]
    v_mfma_f32_16x16x32_bf16 v[44:47], a[100:103], a[116:119], v[44:47]
    buffer_load_dwordx4 a[28:31], v1, s[32:35], s75 offen offset:3072 sc1
    s_setprio 0
    s_waitcnt vmcnt(3)
    v_mfma_f32_16x16x32_bf16 v[8:11], v[80:83], a[24:27], 0
    v_mfma_f32_16x16x32_bf16 v[12:15], v[84:87], a[24:27], 0
    v_mfma_f32_16x16x32_bf16 v[16:19], v[88:91], a[24:27], 0
    v_mfma_f32_16x16x32_bf16 v[20:23], v[92:95], a[24:27], 0
    v_mfma_f32_16x16x32_bf16 v[24:27], v[96:99], a[24:27], 0
    s_add_u32 s75, s66, 102400
    buffer_load_dwordx4 a[68:71], v1, s[32:35], s75 offen offset:0 sc1
    s_waitcnt vmcnt(3)
    v_mfma_f32_16x16x32_bf16 v[8:11], v[100:103], a[64:67], v[8:11]
    v_mfma_f32_16x16x32_bf16 v[12:15], v[104:107], a[64:67], v[12:15]
    v_mfma_f32_16x16x32_bf16 v[16:19], v[108:111], a[64:67], v[16:19]
    ds_write_b128 v68, v[28:31] offset:0
    v_mfma_f32_16x16x32_bf16 v[20:23], v[112:115], a[64:67], v[20:23]
    v_mfma_f32_16x16x32_bf16 v[24:27], v[116:119], a[64:67], v[24:27]
    buffer_load_dwordx4 a[108:111], v1, s[32:35], s75 offen offset:1024 sc1
    s_setprio 3
    s_waitcnt vmcnt(3)
    v_mfma_f32_16x16x32_bf16 v[8:11], v[120:123], a[104:107], v[8:11]
    v_mfma_f32_16x16x32_bf16 v[12:15], v[124:127], a[104:107], v[12:15]
    v_mfma_f32_16x16x32_bf16 v[16:19], a[84:87], a[104:107], v[16:19]
    ds_write_b128 v68, v[32:35] offset:8192
    v_mfma_f32_16x16x32_bf16 v[20:23], a[8:11], a[104:107], v[20:23]
    v_mfma_f32_16x16x32_bf16 v[24:27], a[48:51], a[104:107], v[24:27]
    s_add_u32 s75, s66, 147456
    buffer_load_dwordx4 a[32:35], v1, s[32:35], s75 offen offset:0 sc1
    s_waitcnt vmcnt(3)
    v_mfma_f32_16x16x32_bf16 v[8:11], a[88:91], a[28:31], v[8:11]
    v_mfma_f32_16x16x32_bf16 v[12:15], a[12:15], a[28:31], v[12:15]
    v_mfma_f32_16x16x32_bf16 v[16:19], a[52:55], a[28:31], v[16:19]
    ds_write_b128 v68, v[36:39] offset:16384
    v_mfma_f32_16x16x32_bf16 v[20:23], a[92:95], a[28:31], v[20:23]
    v_mfma_f32_16x16x32_bf16 v[24:27], a[16:19], a[28:31], v[24:27]
    buffer_load_dwordx4 a[72:75], v1, s[32:35], s75 offen offset:1024 sc1
    s_setprio 2
    s_waitcnt vmcnt(3)
    v_mfma_f32_16x16x32_bf16 v[8:11], a[56:59], a[68:71], v[8:11]
    v_mfma_f32_16x16x32_bf16 v[12:15], a[96:99], a[68:71], v[12:15]
    v_mfma_f32_16x16x32_bf16 v[16:19], a[20:23], a[68:71], v[16:19]
    ds_write_b128 v68, v[40:43] offset:24576
    v_mfma_f32_16x16x32_bf16 v[20:23], a[0:3], a[68:71], v[20:23]
    v_mfma_f32_16x16x32_bf16 v[24:27], a[40:43], a[68:71], v[24:27]
    buffer_load_dwordx4 a[112:115], v1, s[32:35], s75 offen offset:2048 sc1
    s_waitcnt vmcnt(3)
    v_mfma_f32_16x16x32_bf16 v[8:11], a[80:83], a[108:111], v[8:11]
    v_mfma_f32_16x16x32_bf16 v[12:15], a[4:7], a[108:111], v[12:15]
    v_mfma_f32_16x16x32_bf16 v[16:19], a[44:47], a[108:111], v[16:19]
    ds_write_b128 v68, v[44:47] offset:32768
    v_add_u32 v68, 40960, v68
    v_mfma_f32_16x16x32_bf16 v[20:23], a[60:63], a[108:111], v[20:23]
    v_mfma_f32_16x16x32_bf16 v[24:27], a[100:103], a[108:111], v[24:27]
    buffer_load_dwordx4 a[36:39], v1, s[32:35], s75 offen offset:3072 sc1
    s_setprio 1
    s_waitcnt vmcnt(3)
    v_mfma_f32_16x16x32_bf16 v[28:31], v[80:83], a[32:35], 0
    v_mfma_f32_16x16x32_bf16 v[32:35], v[84:87], a[32:35], 0
    v_mfma_f32_16x16x32_bf16 v[36:39], v[88:91], a[32:35], 0
    v_mfma_f32_16x16x32_bf16 v[40:43], v[92:95], a[32:35], 0
    v_mfma_f32_16x16x32_bf16 v[44:47], v[96:99], a[32:35], 0
    s_add_u32 s75, s66, 151552
    buffer_load_dwordx4 a[76:79], v1, s[32:35], s75 offen offset:0 sc1
    s_waitcnt vmcnt(3)
    v_mfma_f32_16x16x32_bf16 v[28:31], v[100:103], a[72:75], v[28:31]
    v_mfma_f32_16x16x32_bf16 v[32:35], v[104:107], a[72:75], v[32:35]
    v_mfma_f32_16x16x32_bf16 v[36:39], v[108:111], a[72:75], v[36:39]
    ds_write_b128 v68, v[8:11] offset:0
    v_mfma_f32_16x16x32_bf16 v[40:43], v[112:115], a[72:75], v[40:43]
    v_mfma_f32_16x16x32_bf16 v[44:47], v[116:119], a[72:75], v[44:47]
    buffer_load_dwordx4 a[116:119], v1, s[32:35], s75 offen offset:1024 sc1
    s_setprio 0
    s_waitcnt vmcnt(3)
    v_mfma_f32_16x16x32_bf16 v[28:31], v[120:123], a[112:115], v[28:31]
    v_mfma_f32_16x16x32_bf16 v[32:35], v[124:127], a[112:115], v[32:35]
    v_mfma_f32_16x16x32_bf16 v[36:39], a[84:87], a[112:115], v[36:39]
    ds_write_b128 v68, v[12:15] offset:8192
    v_mfma_f32_16x16x32_bf16 v[40:43], a[8:11], a[112:115], v[40:43]
    v_mfma_f32_16x16x32_bf16 v[44:47], a[48:51], a[112:115], v[44:47]
    s_waitcnt vmcnt(2)
    v_mfma_f32_16x16x32_bf16 v[28:31], a[88:91], a[36:39], v[28:31]
    v_mfma_f32_16x16x32_bf16 v[32:35], a[12:15], a[36:39], v[32:35]
    v_mfma_f32_16x16x32_bf16 v[36:39], a[52:55], a[36:39], v[36:39]
    ds_write_b128 v68, v[16:19] offset:16384
    v_mfma_f32_16x16x32_bf16 v[40:43], a[92:95], a[36:39], v[40:43]
    v_mfma_f32_16x16x32_bf16 v[44:47], a[16:19], a[36:39], v[44:47]
    s_setprio 3
    s_waitcnt vmcnt(1)
    ds_write_b128 v68, v[20:23] offset:24576
    ds_write_b128 v68, v[24:27] offset:32768
    v_add_u32 v68, 40960, v68
    s_waitcnt vmcnt(0)
    v_mfma_f32_16x16x32_bf16 v[28:31], a[56:59], a[76:79], v[28:31]
    v_mfma_f32_16x16x32_bf16 v[28:31], a[80:83], a[116:119], v[28:31]
    v_and_b32 v70, 15, v0
    v_mul_u32_u24 v70, 1280, v70
    v_and_b32 v66, 16, v0
    v_lshl_add_u32 v71, v66, 1, v70
    v_lshrrev_b32 v66, 5, v0
    v_mfma_f32_16x16x32_bf16 v[32:35], a[96:99], a[76:79], v[32:35]
    v_mfma_f32_16x16x32_bf16 v[32:35], a[4:7], a[116:119], v[32:35]
    v_lshl_add_u32 v71, v66, 4, v71
    v_lshrrev_b32 v66, 4, v0
    v_lshl_add_u32 v70, v66, 3, v70
    s_mul_i32 s70, s63, 40960
    v_add_u32 v69, s70, v1
    ds_write_b128 v68, v[28:31] offset:0
    v_mfma_f32_16x16x32_bf16 v[36:39], a[20:23], a[76:79], v[36:39]
    v_mfma_f32_16x16x32_bf16 v[36:39], a[44:47], a[116:119], v[36:39]
    s_lshl_b32 s71, s43, 6
    s_add_u32 s71, s71, s67
    v_lshlrev_b32 v48, 16, v2
    v_and_b32 v49, 0xffff0000, v2
    v_lshlrev_b32 v50, 16, v3
    ds_write_b128 v68, v[32:35] offset:8192
    v_mfma_f32_16x16x32_bf16 v[40:43], a[0:3], a[76:79], v[40:43]
    v_mfma_f32_16x16x32_bf16 v[40:43], a[60:63], a[116:119], v[40:43]
    v_and_b32 v51, 0xffff0000, v3
    v_lshlrev_b32 v52, 16, v4
    v_and_b32 v53, 0xffff0000, v4
    v_lshlrev_b32 v54, 16, v5
    v_and_b32 v55, 0xffff0000, v5
    ds_write_b128 v68, v[36:39] offset:16384
    v_mfma_f32_16x16x32_bf16 v[44:47], a[40:43], a[76:79], v[44:47]
    v_mfma_f32_16x16x32_bf16 v[44:47], a[100:103], a[116:119], v[44:47]
    v_lshlrev_b32 v56, 16, v6
    v_and_b32 v57, 0xffff0000, v6
    v_lshlrev_b32 v58, 16, v7
    v_and_b32 v59, 0xffff0000, v7
    ds_write_b128 v68, v[40:43] offset:24576
    s_nop 2
    ds_write_b128 v68, v[44:47] offset:32768
    v_add_u32 v68, 40960, v68
    s_lshl_b32 s70, s43, 14
    v_add_u32 v68, s70, v69
    s_waitcnt lgkmcnt(0)
    s_barrier
    ds_read_b128 v[72:75], v68 offset:0
    ds_read_b128 v[76:79], v68 offset:8192
    ds_read_b128 v[80:83], v68 offset:1024
    ds_read_b128 v[84:87], v68 offset:9216
    ds_read_b128 v[88:91], v68 offset:2048
    ds_read_b128 v[92:95], v68 offset:10240
    ds_read_b128 v[96:99], v68 offset:3072
    ds_read_b128 v[100:103], v68 offset:11264
    ds_read_b128 v[104:107], v68 offset:4096
    ds_read_b128 v[108:111], v68 offset:12288
    ds_read_b128 v[112:115], v68 offset:5120
    ds_read_b128 v[116:119], v68 offset:13312
    ds_read_b128 v[120:123], v68 offset:6144
    ds_read_b128 v[124:127], v68 offset:14336
    s_waitcnt lgkmcnt(12)
    ds_read_b128 v[8:11], v68 offset:7168
    ds_read_b128 v[12:15], v68 offset:15360
    s_waitcnt lgkmcnt(6)
    s_cmp_lg_u32 s43, 0
    s_cbranch_scc1 L_no4r
    ds_read_b128 v[16:19], v69 offset:32768
    ds_read_b128 v[20:23], v69 offset:33792
    ds_read_b128 v[24:27], v69 offset:34816
    ds_read_b128 v[28:31], v69 offset:35840
    ds_read_b128 v[32:35], v69 offset:36864
    ds_read_b128 v[36:39], v69 offset:37888
    ds_read_b128 v[40:43], v69 offset:38912
    ds_read_b128 v[44:47], v69 offset:39936
    v_pk_add_f32 v[48:49], v[48:49], v[72:73]
    v_pk_add_f32 v[50:51], v[50:51], v[74:75]
    v_pk_add_f32 v[52:53], v[52:53], v[76:77]
    v_pk_add_f32 v[54:55], v[54:55], v[78:79]
    v_pk_add_f32 v[48:49], v[48:49], v[80:81]
    v_pk_add_f32 v[50:51], v[50:51], v[82:83]
    v_pk_add_f32 v[52:53], v[52:53], v[84:85]
    v_pk_add_f32 v[54:55], v[54:55], v[86:87]
    v_pk_add_f32 v[48:49], v[48:49], v[88:89]
    v_pk_add_f32 v[50:51], v[50:51], v[90:91]
    v_pk_add_f32 v[52:53], v[52:53], v[92:93]
    v_pk_add_f32 v[54:55], v[54:55], v[94:95]
    v_pk_add_f32 v[48:49], v[48:49], v[96:97]
    v_pk_add_f32 v[50:51], v[50:51], v[98:99]
    v_pk_add_f32 v[52:53], v[52:53], v[100:101]
    v_pk_add_f32 v[54:55], v[54:55], v[102:103]
    v_pk_add_f32 v[48:49], v[48:49], v[104:105]
    v_pk_add_f32 v[50:51], v[50:51], v[106:107]
    v_pk_add_f32 v[52:53], v[52:53], v[108:109]
    v_pk_add_f32 v[54:55], v[54:55], v[110:111]
    s_waitcnt lgkmcnt(8)
    s_branch L_red
L_no4r:
    v_pk_add_f32 v[48:49], v[48:49], v[72:73]
    v_pk_add_f32 v[50:51], v[50:51], v[74:75]
    v_pk_add_f32 v[52:53], v[52:53], v[76:77]
    v_pk_add_f32 v[54:55], v[54:55], v[78:79]
    v_pk_add_f32 v[48:49], v[48:49], v[80:81]
    v_pk_add_f32 v[50:51], v[50:51], v[82:83]
    v_pk_add_f32 v[52:53], v[52:53], v[84:85]
    v_pk_add_f32 v[54:55], v[54:55], v[86:87]
    v_pk_add_f32 v[48:49], v[48:49], v[88:89]
    v_pk_add_f32 v[50:51], v[50:51], v[90:91]
    v_pk_add_f32 v[52:53], v[52:53], v[92:93]
    v_pk_add_f32 v[54:55], v[54:55], v[94:95]
    v_pk_add_f32 v[48:49], v[48:49], v[96:97]
    v_pk_add_f32 v[50:51], v[50:51], v[98:99]
    v_pk_add_f32 v[52:53], v[52:53], v[100:101]
    v_pk_add_f32 v[54:55], v[54:55], v[102:103]
    v_pk_add_f32 v[48:49], v[48:49], v[104:105]
    v_pk_add_f32 v[50:51], v[50:51], v[106:107]
    v_pk_add_f32 v[52:53], v[52:53], v[108:109]
    v_pk_add_f32 v[54:55], v[54:55], v[110:111]
    s_waitcnt lgkmcnt(0)
L_red:
    v_pk_add_f32 v[48:49], v[48:49], v[112:113]
    v_pk_add_f32 v[50:51], v[50:51], v[114:115]
    v_pk_add_f32 v[52:53], v[52:53], v[116:117]
    v_pk_add_f32 v[54:55], v[54:55], v[118:119]
    v_pk_add_f32 v[48:49], v[48:49], v[120:121]
    v_pk_add_f32 v[50:51], v[50:51], v[122:123]
    v_pk_add_f32 v[52:53], v[52:53], v[124:125]
    v_pk_add_f32 v[54:55], v[54:55], v[126:127]
    v_pk_add_f32 v[48:49], v[48:49], v[8:9]
    v_pk_add_f32 v[50:51], v[50:51], v[10:11]
    v_pk_add_f32 v[52:53], v[52:53], v[12:13]
    v_pk_add_f32 v[54:55], v[54:55], v[14:15]
    v_cvt_pk_bf16_f32 v60, v48, v49
    v_cvt_pk_bf16_f32 v61, v50, v51
    v_cvt_pk_bf16_f32 v62, v52, v53
    v_cvt_pk_bf16_f32 v63, v54, v55
    s_nop 0
    v_permlane16_swap_b32 v60, v62
    v_permlane16_swap_b32 v61, v63
    buffer_store_dwordx4 v[60:63], v71, s[24:27], s71 offen
    s_cmp_lg_u32 s43, 0
    s_cbranch_scc1 L_fin
    s_waitcnt lgkmcnt(0)
    v_pk_add_f32 v[56:57], v[56:57], v[16:17]
    v_pk_add_f32 v[58:59], v[58:59], v[18:19]
    v_pk_add_f32 v[56:57], v[56:57], v[20:21]
    v_pk_add_f32 v[58:59], v[58:59], v[22:23]
    v_pk_add_f32 v[56:57], v[56:57], v[24:25]
    v_pk_add_f32 v[58:59], v[58:59], v[26:27]
    v_pk_add_f32 v[56:57], v[56:57], v[28:29]
    v_pk_add_f32 v[58:59], v[58:59], v[30:31]
    v_pk_add_f32 v[56:57], v[56:57], v[32:33]
    v_pk_add_f32 v[58:59], v[58:59], v[34:35]
    v_pk_add_f32 v[56:57], v[56:57], v[36:37]
    v_pk_add_f32 v[58:59], v[58:59], v[38:39]
    v_pk_add_f32 v[56:57], v[56:57], v[40:41]
    v_pk_add_f32 v[58:59], v[58:59], v[42:43]
    v_pk_add_f32 v[56:57], v[56:57], v[44:45]
    v_pk_add_f32 v[58:59], v[58:59], v[46:47]
    v_cvt_pk_bf16_f32 v64, v56, v57
    v_cvt_pk_bf16_f32 v65, v58, v59
    buffer_store_dwordx2 v[64:65], v70, s[24:27], s67 offen offset:128
L_fin:
    s_endpgm
L_st_26_s:
    s_nop 4
    buffer_store_dwordx4 v[36:39], v33, s[32:35], s48 offen sc1
    s_branch L_st_26_b
L_st_27_s:
    s_nop 4
    buffer_store_dwordx2 v[40:41], v32, s[32:35], s49 offen sc1
    s_branch L_st_27_b
L_st_29_s:
    s_nop 4
    buffer_store_dwordx2 v[28:29], off, s[32:35], s70 sc1
    s_branch L_st_29_b
L_st_36_s:
    s_nop 4
    buffer_store_dwordx4 v[2:5], v1, s[32:35], s53 offen sc1
    s_branch L_st_36_b
L_st_37_s:
    s_nop 4
    buffer_store_dwordx4 v[36:39], v31, s[32:35], s54 offen sc1
    s_branch L_st_37_b
L_st_38_s:
    s_nop 4
    buffer_store_dwordx2 v[44:45], v1, s[32:35], s55 offen sc1
    s_branch L_st_38_b
L_st_40_s:
    s_nop 4
    buffer_store_dwordx2 v[28:29], off, s[32:35], s70 sc1
    s_branch L_st_40_b
L_st_44_s:
    s_nop 4
    buffer_store_dwordx2 v[28:29], off, s[32:35], s70 sc1
    s_branch L_st_44_b
L_st_47_s:
    s_nop 4
    buffer_store_dwordx4 v[44:47], v1, s[32:35], s64 offen sc1
    s_branch L_st_47_b
L_st_48_s:
    s_nop 4
    buffer_store_dwordx4 v[20:23], v53, s[32:35], s65 offen sc1
    s_branch L_st_48_b
L_st_49_s:
    s_nop 4
    buffer_store_dwordx2 v[54:55], off, s[32:35], s70 sc1
    s_branch L_st_49_b
L_st_52_s:
    s_nop 4
    buffer_store_dwordx4 v[44:47], v1, s[32:35], s64 offen sc1
    s_branch L_st_52_b
L_st_53_s:
    s_nop 4
    buffer_store_dwordx4 v[32:35], v53, s[32:35], s65 offen sc1
    s_branch L_st_53_b
L_st_54_s:
    s_nop 4
    buffer_store_dwordx2 v[54:55], off, s[32:35], s70 sc1
    s_branch L_st_54_b
L_slow:
    s_setprio 0
    s_nop 15
    s_waitcnt vmcnt(0) lgkmcnt(0)
    v_cndmask_b32 v28, 0, v28, s[90:91]
    v_mov_b32 v48, 0xff800000
    v_mov_b32 v8, 0
    v_mov_b32 v9, 0
    v_mov_b32 v10, 0
    v_mov_b32 v11, 0
    v_mov_b32 v12, 0
    v_mov_b32 v13, 0
    v_mov_b32 v14, 0
    v_mov_b32 v15, 0
    v_mov_b32 v16, 0
    v_mov_b32 v17, 0
    v_mov_b32 v18, 0
    v_mov_b32 v19, 0
    v_mov_b32 v20, 0
    v_mov_b32 v21, 0
    v_mov_b32 v22, 0
    v_mov_b32 v23, 0
    s_mul_i32 s68, s36, 196608
    s_add_u32 s68, s68, 6291456
    s_mul_i32 s0, s63, 20
    s_mul_i32 s1, s43, 10
    s_add_u32 s0, s0, s1
    s_lshl_b32 s0, s0, 10
    s_add_u32 s50, s0, s68
    s_add_u32 s51, s50, 4096
    s_add_u32 s52, s50, 8192
    s_lshr_b32 s0, s37, 1
    s_mul_i32 s0, s0, 5
    s_mul_i32 s1, s44, 40
    s_add_u32 s0, s0, s1
    s_lshl_b32 s0, s0, 10
    s_add_u32 s68, s68, s0
    s_and_b32 s1, s37, 1
    s_lshl_b32 s1, s1, 2
    s_add_u32 s1, s1, s45
    s_lshl_b32 s0, s1, 9
    s_add_u32 s48, s0, s68
    s_lshr_b32 s0, s1, 1
    s_lshl_b32 s0, s0, 8
    s_and_b32 s1, s1, 1
    s_lshl_b32 s1, s1, 3
    s_add_u32 s0, s0, s1
    s_add_u32 s0, s0, s68
    s_add_u32 s49, s0, 4096
    s_lshr_b32 s0, s37, 1
    s_mul_i32 s0, s0, 5
    s_mul_i32 s1, s63, 20
    s_add_u32 s0, s0, s1
    s_lshl_b32 s0, s0, 10
    s_add_u32 s68, s0, s6
    s_and_b32 s1, s37, 1
    s_lshl_b32 s1, s1, 1
    s_add_u32 s0, s1, s43
    s_lshl_b32 s0, s0, 10
    s_add_u32 s53, s0, s68
    s_lshl_b32 s1, s1, 8
    s_add_u32 s0, s1, s68
    s_add_u32 s54, s0, 4096
    s_lshr_b32 s0, s37, 1
    s_lshl_b32 s0, s0, 8
    s_lshl_b32 s1, s1, 1
    s_add_u32 s0, s0, s1
    s_lshl_b32 s1, s43, 3
    s_add_u32 s0, s0, s1
    s_lshl_b32 s1, s63, 11
    s_add_u32 s0, s0, s1
    s_add_u32 s0, s0, s6
    s_add_u32 s55, s0, 81920
    s_mul_i32 s68, s36, 196608
    s_add_u32 s68, s68, 6291456
    s_mul_i32 s0, s38, 6144
    s_add_u32 s66, s0, s68
    s_mul_i32 s0, s44, 48
    s_mul_i32 s1, s37, 6
    s_add_u32 s0, s0, s1
    s_lshl_b32 s0, s0, 10
    s_add_u32 s68, s68, s0
    s_lshl_b32 s0, s45, 10
    s_add_u32 s64, s0, s68
    s_lshl_b32 s0, s45, 9
    s_add_u32 s0, s0, s68
    s_add_u32 s65, s0, 4096
    ds_write_b128 v91, a[32:35] offset:0
    ds_write_b128 v91, a[36:39] offset:9216
    ds_write_b128 v91, a[40:43] offset:18432
    s_waitcnt lgkmcnt(0)
    s_barrier
    ds_read_b64_tr_b16 v[96:97], v92
    ds_read_b64_tr_b16 v[98:99], v93
    ds_read_b64_tr_b16 v[100:101], v120
    ds_read_b64_tr_b16 v[102:103], v121
    ds_read_b64_tr_b16 v[104:105], v122
    ds_read_b64_tr_b16 v[106:107], v123
    s_waitcnt lgkmcnt(0)
    buffer_store_dwordx4 v[96:99], v1, s[32:35], s88 offen offset:0 sc1
    buffer_store_dwordx4 v[100:103], v1, s[32:35], s88 offen offset:2048 sc1
    buffer_store_dwordx4 v[104:107], v1, s[32:35], s89 offen offset:0 sc1
    v_mov_b32 v108, s42
    v_mov_b32 v109, s42
    v_mov_b32 v110, s42
    v_mov_b32 v111, s42
    s_nop 1
    v_mfma_f32_16x16x32_bf16 v[112:115], v[96:99], v[108:111], 0
    v_mfma_f32_16x16x32_bf16 v[112:115], v[100:103], v[108:111], v[112:115]
    s_cmp_lg_u32 s44, 0
    s_cbranch_scc1 L_tm_57
    v_mfma_f32_16x16x32_bf16 v[112:115], v[104:107], v[108:111], v[112:115]
L_tm_57:
    s_nop 7
    s_mov_b64 exec, 0x10001
    s_mov_b32 exec_hi, 0x10001
    buffer_store_dwordx4 v[112:115], v0, s[32:35], s62 offen sc1
    s_mov_b64 exec, -1
    s_waitcnt vmcnt(0)
    s_barrier
    s_getreg_b32 s71, hwreg(HW_REG_XCC_ID)
    s_and_b32 s71, s71, 15
    s_lshl_b32 s70, s5, 7
    s_add_u32 s70, s70, 16384
    s_cmp_eq_u32 s38, 0
    s_cselect_b32 s70, s70, 0x7f000000
    v_mov_b32 v120, s40
    v_mov_b32 v121, s41
    v_mov_b32 v122, s71
    s_mov_b64 exec, 1
    buffer_store_dwordx3 v[120:122], off, s[32:35], s70 sc1
    s_mov_b64 exec, -1
    s_mov_b32 s72, 0
    s_mul_i32 s73, s38, 1344
L_sq:
    s_waitcnt vmcnt(0) lgkmcnt(0)
    s_barrier
    s_mul_i32 s70, s72, 10752
    s_add_u32 s70, s70, s73
    s_add_u32 s70, s70, 262144
    s_add_u32 m0, s73, 102400
    s_nop 0
    buffer_load_dwordx4 v1, s[32:35], s70 offen sc1 lds
    s_mov_b64 exec, 0xfffff
    buffer_load_dwordx4 v1, s[32:35], s70 offen offset:1024 sc1 lds
    s_mov_b64 exec, -1
    s_waitcnt vmcnt(0)
    s_barrier
    ds_read_b128 v[64:67], v30 offset:0
    ds_read_b64 v[68:69], v71 offset:0
    ds_read_b128 v[72:75], v70 offset:1280
    ds_read_b128 v[76:79], v70 offset:1984
    s_waitcnt lgkmcnt(0)
    v_mfma_f32_32x32x16_bf16 v[32:47], v[64:67], v[24:27], 0
    v_mfma_f32_32x32x8_bf16 v[32:47], v[68:69], v[28:29], v[32:47]
    s_nop 11
    v_max3_f32 v49, v48, v32, v33
    v_max3_f32 v49, v49, v34, v35
    v_max3_f32 v49, v49, v36, v37
    v_max3_f32 v49, v49, v38, v39
    v_max3_f32 v49, v49, v40, v41
    v_max3_f32 v49, v49, v42, v43
    v_max3_f32 v49, v49, v44, v45
    v_max3_f32 v49, v49, v46, v47
    v_mov_b32 v51, v49
    s_nop 1
    v_permlane32_swap_b32 v49, v51
    v_max_f32 v49, v49, v51
    v_sub_f32 v50, v48, v49
    v_exp_f32 v50, v50
    v_mov_b32 v48, v49
    v_sub_f32 v32, v32, v49
    v_sub_f32 v33, v33, v49
    v_sub_f32 v34, v34, v49
    v_sub_f32 v35, v35, v49
    v_sub_f32 v36, v36, v49
    v_sub_f32 v37, v37, v49
    v_sub_f32 v38, v38, v49
    v_sub_f32 v39, v39, v49
    v_sub_f32 v40, v40, v49
    v_sub_f32 v41, v41, v49
    v_sub_f32 v42, v42, v49
    v_sub_f32 v43, v43, v49
    v_sub_f32 v44, v44, v49
    v_sub_f32 v45, v45, v49
    v_sub_f32 v46, v46, v49
    v_sub_f32 v47, v47, v49
    v_exp_f32 v32, v32
    v_exp_f32 v33, v33
    v_exp_f32 v34, v34
    v_exp_f32 v35, v35
    v_exp_f32 v36, v36
    v_exp_f32 v37, v37
    v_exp_f32 v38, v38
    v_exp_f32 v39, v39
    v_exp_f32 v40, v40
    v_exp_f32 v41, v41
    v_exp_f32 v42, v42
    v_exp_f32 v43, v43
    v_exp_f32 v44, v44
    v_exp_f32 v45, v45
    v_exp_f32 v46, v46
    v_exp_f32 v47, v47
    v_mul_f32 v8, v50, v8
    v_mul_f32 v9, v50, v9
    v_mul_f32 v10, v50, v10
    v_mul_f32 v11, v50, v11
    v_mul_f32 v12, v50, v12
    v_mul_f32 v13, v50, v13
    v_mul_f32 v14, v50, v14
    v_mul_f32 v15, v50, v15
    v_mul_f32 v16, v50, v16
    v_mul_f32 v17, v50, v17
    v_mul_f32 v18, v50, v18
    v_mul_f32 v19, v50, v19
    v_cvt_pk_bf16_f32 v32, v32, v33
    v_cvt_pk_bf16_f32 v33, v34, v35
    v_cvt_pk_bf16_f32 v34, v36, v37
    v_cvt_pk_bf16_f32 v35, v38, v39
    v_cvt_pk_bf16_f32 v36, v40, v41
    v_cvt_pk_bf16_f32 v37, v42, v43
    v_cvt_pk_bf16_f32 v38, v44, v45
    v_cvt_pk_bf16_f32 v39, v46, v47
    v_mfma_f32_32x32x16_bf16 v[8:23], v[72:75], v[32:35], v[8:23]
    s_nop 0
    v_mfma_f32_32x32x16_bf16 v[8:23], v[76:79], v[36:39], v[8:23]
    s_nop 11
    ds_read_b128 v[64:67], v30 offset:2688
    ds_read_b64 v[68:69], v71 offset:2688
    ds_read_b128 v[72:75], v70 offset:3968
    ds_read_b128 v[76:79], v70 offset:4672
    s_waitcnt lgkmcnt(0)
    v_mfma_f32_32x32x16_bf16 v[32:47], v[64:67], v[24:27], 0
    v_mfma_f32_32x32x8_bf16 v[32:47], v[68:69], v[28:29], v[32:47]
    s_nop 11
    v_max3_f32 v49, v48, v32, v33
    v_max3_f32 v49, v49, v34, v35
    v_max3_f32 v49, v49, v36, v37
    v_max3_f32 v49, v49, v38, v39
    v_max3_f32 v49, v49, v40, v41
    v_max3_f32 v49, v49, v42, v43
    v_max3_f32 v49, v49, v44, v45
    v_max3_f32 v49, v49, v46, v47
    v_mov_b32 v51, v49
    s_nop 1
    v_permlane32_swap_b32 v49, v51
    v_max_f32 v49, v49, v51
    v_sub_f32 v50, v48, v49
    v_exp_f32 v50, v50
    v_mov_b32 v48, v49
    v_sub_f32 v32, v32, v49
    v_sub_f32 v33, v33, v49
    v_sub_f32 v34, v34, v49
    v_sub_f32 v35, v35, v49
    v_sub_f32 v36, v36, v49
    v_sub_f32 v37, v37, v49
    v_sub_f32 v38, v38, v49
    v_sub_f32 v39, v39, v49
    v_sub_f32 v40, v40, v49
    v_sub_f32 v41, v41, v49
    v_sub_f32 v42, v42, v49
    v_sub_f32 v43, v43, v49
    v_sub_f32 v44, v44, v49
    v_sub_f32 v45, v45, v49
    v_sub_f32 v46, v46, v49
    v_sub_f32 v47, v47, v49
    v_exp_f32 v32, v32
    v_exp_f32 v33, v33
    v_exp_f32 v34, v34
    v_exp_f32 v35, v35
    v_exp_f32 v36, v36
    v_exp_f32 v37, v37
    v_exp_f32 v38, v38
    v_exp_f32 v39, v39
    v_exp_f32 v40, v40
    v_exp_f32 v41, v41
    v_exp_f32 v42, v42
    v_exp_f32 v43, v43
    v_exp_f32 v44, v44
    v_exp_f32 v45, v45
    v_exp_f32 v46, v46
    v_exp_f32 v47, v47
    v_mul_f32 v8, v50, v8
    v_mul_f32 v9, v50, v9
    v_mul_f32 v10, v50, v10
    v_mul_f32 v11, v50, v11
    v_mul_f32 v12, v50, v12
    v_mul_f32 v13, v50, v13
    v_mul_f32 v14, v50, v14
    v_mul_f32 v15, v50, v15
    v_mul_f32 v16, v50, v16
    v_mul_f32 v17, v50, v17
    v_mul_f32 v18, v50, v18
    v_mul_f32 v19, v50, v19
    v_cvt_pk_bf16_f32 v32, v32, v33
    v_cvt_pk_bf16_f32 v33, v34, v35
    v_cvt_pk_bf16_f32 v34, v36, v37
    v_cvt_pk_bf16_f32 v35, v38, v39
    v_cvt_pk_bf16_f32 v36, v40, v41
    v_cvt_pk_bf16_f32 v37, v42, v43
    v_cvt_pk_bf16_f32 v38, v44, v45
    v_cvt_pk_bf16_f32 v39, v46, v47
    v_mfma_f32_32x32x16_bf16 v[8:23], v[72:75], v[32:35], v[8:23]
    s_nop 0
    v_mfma_f32_32x32x16_bf16 v[8:23], v[76:79], v[36:39], v[8:23]
    s_nop 11
    ds_read_b128 v[64:67], v30 offset:5376
    ds_read_b64 v[68:69], v71 offset:5376
    ds_read_b128 v[72:75], v70 offset:6656
    ds_read_b128 v[76:79], v70 offset:7360
    s_waitcnt lgkmcnt(0)
    v_mfma_f32_32x32x16_bf16 v[32:47], v[64:67], v[24:27], 0
    v_mfma_f32_32x32x8_bf16 v[32:47], v[68:69], v[28:29], v[32:47]
    s_nop 11
    v_max3_f32 v49, v48, v32, v33
    v_max3_f32 v49, v49, v34, v35
    v_max3_f32 v49, v49, v36, v37
    v_max3_f32 v49, v49, v38, v39
    v_max3_f32 v49, v49, v40, v41
    v_max3_f32 v49, v49, v42, v43
    v_max3_f32 v49, v49, v44, v45
    v_max3_f32 v49, v49, v46, v47
    v_mov_b32 v51, v49
    s_nop 1
    v_permlane32_swap_b32 v49, v51
    v_max_f32 v49, v49, v51
    v_sub_f32 v50, v48, v49
    v_exp_f32 v50, v50
    v_mov_b32 v48, v49
    v_sub_f32 v32, v32, v49
    v_sub_f32 v33, v33, v49
    v_sub_f32 v34, v34, v49
    v_sub_f32 v35, v35, v49
    v_sub_f32 v36, v36, v49
    v_sub_f32 v37, v37, v49
    v_sub_f32 v38, v38, v49
    v_sub_f32 v39, v39, v49
    v_sub_f32 v40, v40, v49
    v_sub_f32 v41, v41, v49
    v_sub_f32 v42, v42, v49
    v_sub_f32 v43, v43, v49
    v_sub_f32 v44, v44, v49
    v_sub_f32 v45, v45, v49
    v_sub_f32 v46, v46, v49
    v_sub_f32 v47, v47, v49
    v_exp_f32 v32, v32
    v_exp_f32 v33, v33
    v_exp_f32 v34, v34
    v_exp_f32 v35, v35
    v_exp_f32 v36, v36
    v_exp_f32 v37, v37
    v_exp_f32 v38, v38
    v_exp_f32 v39, v39
    v_exp_f32 v40, v40
    v_exp_f32 v41, v41
    v_exp_f32 v42, v42
    v_exp_f32 v43, v43
    v_exp_f32 v44, v44
    v_exp_f32 v45, v45
    v_exp_f32 v46, v46
    v_exp_f32 v47, v47
    v_mul_f32 v8, v50, v8
    v_mul_f32 v9, v50, v9
    v_mul_f32 v10, v50, v10
    v_mul_f32 v11, v50, v11
    v_mul_f32 v12, v50, v12
    v_mul_f32 v13, v50, v13
    v_mul_f32 v14, v50, v14
    v_mul_f32 v15, v50, v15
    v_mul_f32 v16, v50, v16
    v_mul_f32 v17, v50, v17
    v_mul_f32 v18, v50, v18
    v_mul_f32 v19, v50, v19
    v_cvt_pk_bf16_f32 v32, v32, v33
    v_cvt_pk_bf16_f32 v33, v34, v35
    v_cvt_pk_bf16_f32 v34, v36, v37
    v_cvt_pk_bf16_f32 v35, v38, v39
    v_cvt_pk_bf16_f32 v36, v40, v41
    v_cvt_pk_bf16_f32 v37, v42, v43
    v_cvt_pk_bf16_f32 v38, v44, v45
    v_cvt_pk_bf16_f32 v39, v46, v47
    v_mfma_f32_32x32x16_bf16 v[8:23], v[72:75], v[32:35], v[8:23]
    s_nop 0
    v_mfma_f32_32x32x16_bf16 v[8:23], v[76:79], v[36:39], v[8:23]
    s_nop 11
    ds_read_b128 v[64:67], v30 offset:8064
    ds_read_b64 v[68:69], v71 offset:8064
    ds_read_b128 v[72:75], v70 offset:9344
    ds_read_b128 v[76:79], v70 offset:10048
    s_waitcnt lgkmcnt(0)
    v_mfma_f32_32x32x16_bf16 v[32:47], v[64:67], v[24:27], 0
    v_mfma_f32_32x32x8_bf16 v[32:47], v[68:69], v[28:29], v[32:47]
    s_nop 11
    v_max3_f32 v49, v48, v32, v33
    v_max3_f32 v49, v49, v34, v35
    v_max3_f32 v49, v49, v36, v37
    v_max3_f32 v49, v49, v38, v39
    v_max3_f32 v49, v49, v40, v41
    v_max3_f32 v49, v49, v42, v43
    v_max3_f32 v49, v49, v44, v45
    v_max3_f32 v49, v49, v46, v47
    v_mov_b32 v51, v49
    s_nop 1
    v_permlane32_swap_b32 v49, v51
    v_max_f32 v49, v49, v51
    v_sub_f32 v50, v48, v49
    v_exp_f32 v50, v50
    v_mov_b32 v48, v49
    v_sub_f32 v32, v32, v49
    v_sub_f32 v33, v33, v49
    v_sub_f32 v34, v34, v49
    v_sub_f32 v35, v35, v49
    v_sub_f32 v36, v36, v49
    v_sub_f32 v37, v37, v49
    v_sub_f32 v38, v38, v49
    v_sub_f32 v39, v39, v49
    v_sub_f32 v40, v40, v49
    v_sub_f32 v41, v41, v49
    v_sub_f32 v42, v42, v49
    v_sub_f32 v43, v43, v49
    v_sub_f32 v44, v44, v49
    v_sub_f32 v45, v45, v49
    v_sub_f32 v46, v46, v49
    v_sub_f32 v47, v47, v49
    v_exp_f32 v32, v32
    v_exp_f32 v33, v33
    v_exp_f32 v34, v34
    v_exp_f32 v35, v35
    v_exp_f32 v36, v36
    v_exp_f32 v37, v37
    v_exp_f32 v38, v38
    v_exp_f32 v39, v39
    v_exp_f32 v40, v40
    v_exp_f32 v41, v41
    v_exp_f32 v42, v42
    v_exp_f32 v43, v43
    v_exp_f32 v44, v44
    v_exp_f32 v45, v45
    v_exp_f32 v46, v46
    v_exp_f32 v47, v47
    v_mul_f32 v8, v50, v8
    v_mul_f32 v9, v50, v9
    v_mul_f32 v10, v50, v10
    v_mul_f32 v11, v50, v11
    v_mul_f32 v12, v50, v12
    v_mul_f32 v13, v50, v13
    v_mul_f32 v14, v50, v14
    v_mul_f32 v15, v50, v15
    v_mul_f32 v16, v50, v16
    v_mul_f32 v17, v50, v17
    v_mul_f32 v18, v50, v18
    v_mul_f32 v19, v50, v19
    v_cvt_pk_bf16_f32 v32, v32, v33
    v_cvt_pk_bf16_f32 v33, v34, v35
    v_cvt_pk_bf16_f32 v34, v36, v37
    v_cvt_pk_bf16_f32 v35, v38, v39
    v_cvt_pk_bf16_f32 v36, v40, v41
    v_cvt_pk_bf16_f32 v37, v42, v43
    v_cvt_pk_bf16_f32 v38, v44, v45
    v_cvt_pk_bf16_f32 v39, v46, v47
    v_mfma_f32_32x32x16_bf16 v[8:23], v[72:75], v[32:35], v[8:23]
    s_nop 0
    v_mfma_f32_32x32x16_bf16 v[8:23], v[76:79], v[36:39], v[8:23]
    s_nop 11
    s_add_u32 s72, s72, 1
    s_cmp_lt_u32 s72, 16
    s_cbranch_scc1 L_sq
    v_and_b32 v84, 31, v0
    s_lshl_b32 s70, s38, 5
    v_add_u32 v84, s70, v84
    v_lshlrev_b32 v84, 7, v84
    v_add_u32 v84, 16384, v84
    s_mov_b32 s79, 0x200000
L_poll_58:
    buffer_load_dwordx2 v[80:81], v84, s[32:35], 0 offen sc1
    s_sub_u32 s79, s79, 1
    s_cbranch_scc1 L_poll_58_d
    s_waitcnt vmcnt(0)
    v_cmp_ne_u64 vcc, s[40:41], v[80:81]
    s_cbranch_vccnz L_poll_58
L_poll_58_d:
    s_barrier
    v_and_b32 v86, 7, v0
    v_lshlrev_b32 v86, 7, v86
    s_lshl_b32 s70, s36, 10
    s_add_u32 s70, s70, 16384
    buffer_load_dword v87, v86, s[32:35], s70 offen offset:8 sc1
    s_lshl_b32 s70, s43, 6
    s_add_u32 s70, s70, s67
    buffer_load_dwordx2 v[2:3], v94, s[8:11], s70 offen offset:0
    s_lshl_b32 s70, s43, 6
    s_add_u32 s70, s70, s67
    buffer_load_dwordx2 v[4:5], v94, s[8:11], s70 offen offset:32
    buffer_load_dwordx2 v[6:7], v94, s[8:11], s67 offen offset:128
    s_waitcnt vmcnt(0)
    v_readfirstlane_b32 s70, v87
    s_nop 1
    v_cmp_ne_u32 vcc, s70, v87
    s_nop 0
    s_cmp_eq_u64 vcc, 0
    s_cselect_b32 s4, 1, 0
    s_mul_i32 s78, s37, 102400
    s_add_u32 s78, s78, 1048576
    s_add_u32 m0, s77, 0
    s_add_u32 s70, m0, s78
    buffer_load_dwordx4 v1, s[32:35], s70 offen sc1 lds
    s_add_u32 m0, s77, 8192
    s_add_u32 s70, m0, s78
    buffer_load_dwordx4 v1, s[32:35], s70 offen sc1 lds
    s_add_u32 m0, s77, 16384
    s_add_u32 s70, m0, s78
    buffer_load_dwordx4 v1, s[32:35], s70 offen sc1 lds
    s_add_u32 m0, s77, 24576
    s_add_u32 s70, m0, s78
    buffer_load_dwordx4 v1, s[32:35], s70 offen sc1 lds
    s_add_u32 m0, s77, 32768
    s_add_u32 s70, m0, s78
    buffer_load_dwordx4 v1, s[32:35], s70 offen sc1 lds
    s_add_u32 m0, s77, 40960
    s_add_u32 s70, m0, s78
    buffer_load_dwordx4 v1, s[32:35], s70 offen sc1 lds
    s_add_u32 m0, s77, 49152
    s_add_u32 s70, m0, s78
    buffer_load_dwordx4 v1, s[32:35], s70 offen sc1 lds
    s_add_u32 m0, s77, 57344
    s_add_u32 s70, m0, s78
    buffer_load_dwordx4 v1, s[32:35], s70 offen sc1 lds
    s_add_u32 m0, s77, 65536
    s_add_u32 s70, m0, s78
    buffer_load_dwordx4 v1, s[32:35], s70 offen sc1 lds
    s_add_u32 m0, s77, 73728
    s_add_u32 s70, m0, s78
    buffer_load_dwordx4 v1, s[32:35], s70 offen sc1 lds
    s_add_u32 m0, s77, 81920
    s_add_u32 s70, m0, s78
    buffer_load_dwordx4 v1, s[32:35], s70 offen sc1 lds
    s_add_u32 m0, s77, 90112
    s_add_u32 s70, m0, s78
    buffer_load_dwordx4 v1, s[32:35], s70 offen sc1 lds
    s_min_u32 s70, s77, 3072
    s_add_u32 m0, s70, 98304
    s_add_u32 s70, m0, s78
    buffer_load_dwordx4 v1, s[32:35], s70 offen sc1 lds
    s_lshl_b32 s70, s37, 2
    s_add_u32 s70, s70, s45
    s_mul_i32 s70, s70, 60
    s_mul_i32 s71, s44, 10
    s_add_u32 s70, s70, s71
    s_lshl_b32 s70, s70, 10
    s_add_u32 s78, s70, 2097152
    buffer_load_dwordx4 a[0:3], v1, s[32:35], s78 offen offset:0 sc1
    buffer_load_dwordx4 a[4:7], v1, s[32:35], s78 offen offset:1024 sc1
    buffer_load_dwordx4 a[8:11], v1, s[32:35], s78 offen offset:2048 sc1
    buffer_load_dwordx4 a[12:15], v1, s[32:35], s78 offen offset:3072 sc1
    s_add_u32 s78, s78, 4096
    buffer_load_dwordx4 a[16:19], v1, s[32:35], s78 offen offset:0 sc1
    buffer_load_dwordx4 a[20:23], v1, s[32:35], s78 offen offset:1024 sc1
    buffer_load_dwordx4 a[24:27], v1, s[32:35], s78 offen offset:2048 sc1
    buffer_load_dwordx4 a[28:31], v1, s[32:35], s78 offen offset:3072 sc1
    s_add_u32 s78, s78, 4096
    buffer_load_dwordx4 a[32:35], v1, s[32:35], s78 offen offset:0 sc1
    buffer_load_dwordx4 a[36:39], v1, s[32:35], s78 offen offset:1024 sc1
    s_add_u32 s78, s78, 12288
    buffer_load_dwordx4 a[40:43], v1, s[32:35], s78 offen offset:0 sc1
    buffer_load_dwordx4 a[44:47], v1, s[32:35], s78 offen offset:1024 sc1
    buffer_load_dwordx4 a[48:51], v1, s[32:35], s78 offen offset:2048 sc1
    buffer_load_dwordx4 a[52:55], v1, s[32:35], s78 offen offset:3072 sc1
    s_add_u32 s78, s78, 4096
    buffer_load_dwordx4 a[56:59], v1, s[32:35], s78 offen offset:0 sc1
    buffer_load_dwordx4 a[60:63], v1, s[32:35], s78 offen offset:1024 sc1
    buffer_load_dwordx4 a[64:67], v1, s[32:35], s78 offen offset:2048 sc1
    buffer_load_dwordx4 a[68:71], v1, s[32:35], s78 offen offset:3072 sc1
    s_add_u32 s78, s78, 4096
    buffer_load_dwordx4 a[72:75], v1, s[32:35], s78 offen offset:0 sc1
    buffer_load_dwordx4 a[76:79], v1, s[32:35], s78 offen offset:1024 sc1
    s_add_u32 s78, s78, 12288
    buffer_load_dwordx4 a[80:83], v1, s[32:35], s78 offen offset:0 sc1
    buffer_load_dwordx4 a[84:87], v1, s[32:35], s78 offen offset:1024 sc1
    buffer_load_dwordx4 a[88:91], v1, s[32:35], s78 offen offset:2048 sc1
    buffer_load_dwordx4 a[92:95], v1, s[32:35], s78 offen offset:3072 sc1
    s_add_u32 s78, s78, 4096
    buffer_load_dwordx4 a[96:99], v1, s[32:35], s78 offen offset:0 sc1
    buffer_load_dwordx4 a[100:103], v1, s[32:35], s78 offen offset:1024 sc1
    buffer_load_dwordx4 a[104:107], v1, s[32:35], s78 offen offset:2048 sc1
    buffer_load_dwordx4 a[108:111], v1, s[32:35], s78 offen offset:3072 sc1
    s_add_u32 s78, s78, 4096
    buffer_load_dwordx4 a[112:115], v1, s[32:35], s78 offen offset:0 sc1
    buffer_load_dwordx4 a[116:119], v1, s[32:35], s78 offen offset:1024 sc1
    s_add_u32 s70, s7, 0
    buffer_load_dwordx4 v[80:83], v1, s[32:35], s70 offen offset:0 sc1
    s_add_u32 s70, s7, 49152
    buffer_load_dwordx4 v[84:87], v1, s[32:35], s70 offen offset:0 sc1
    s_add_u32 s70, s7, 98304
    buffer_load_dwordx4 v[88:91], v1, s[32:35], s70 offen offset:0 sc1
    s_add_u32 s70, s7, 147456
    buffer_load_dwordx4 v[92:95], v1, s[32:35], s70 offen offset:0 sc1
    s_add_u32 s70, s7, 196608
    buffer_load_dwordx4 v[96:99], v1, s[32:35], s70 offen offset:0 sc1
    s_add_u32 s70, s7, 0
    buffer_load_dwordx4 v[100:103], v1, s[32:35], s70 offen offset:1024 sc1
    s_add_u32 s70, s7, 49152
    buffer_load_dwordx4 v[104:107], v1, s[32:35], s70 offen offset:1024 sc1
    s_add_u32 s70, s7, 98304
    buffer_load_dwordx4 v[108:111], v1, s[32:35], s70 offen offset:1024 sc1
    s_add_u32 s70, s7, 147456
    buffer_load_dwordx4 v[112:115], v1, s[32:35], s70 offen offset:1024 sc1
    s_add_u32 s70, s7, 196608
    buffer_load_dwordx4 v[116:119], v1, s[32:35], s70 offen offset:1024 sc1
    s_add_u32 s70, s7, 0
    buffer_load_dwordx4 v[120:123], v1, s[32:35], s70 offen offset:2048 sc1
    s_add_u32 s70, s7, 49152
    buffer_load_dwordx4 v[124:127], v1, s[32:35], s70 offen offset:2048 sc1
    s_cmp_lg_u32 s44, 0
    s_cbranch_scc1 L_tm_59
    v_and_b32 v31, 7, v0
    v_lshlrev_b32 v31, 6, v31
    v_and_or_b32 v31, v0, 48, v31
    s_lshl_b32 s70, s37, 2
    s_add_u32 s70, s70, s45
    s_mul_i32 s70, s70, 1536
    s_add_u32 s71, s70, 524288
    buffer_load_dwordx4 v[24:27], v31, s[32:35], s71 offen offset:0 sc1
    buffer_load_dwordx4 v[44:47], v31, s[32:35], s71 offen offset:512 sc1
    buffer_load_dwordx4 v[64:67], v31, s[32:35], s71 offen offset:1024 sc1
L_tm_59:
    s_waitcnt vmcnt(0)
    s_barrier
    s_branch L_attn_done
L_end:
    s_endpgm
L_code_end:
.section .rodata,"a"
.p2align 6
.amdhsa_kernel sequential_preLN__grouped_kv_mqa__dense_activation_relu__prompt_kernel
  .amdhsa_next_free_vgpr 256
  .amdhsa_next_free_sgpr 102
  .amdhsa_accum_offset 128
  .amdhsa_group_segment_fixed_size 0
  .amdhsa_kernarg_size 88
  .amdhsa_user_sgpr_count 2
  .amdhsa_user_sgpr_kernarg_segment_ptr 1
  .amdhsa_system_sgpr_workgroup_id_x 1
.end_amdhsa_kernel
```
